```python
import torch

def _softmax(x, axis=-1):
    return torch.softmax(x, dim=axis)
def _gelu(x):
    return torch.nn.functional.gelu(x, approximate="tanh")
def _silu(x):
    return torch.nn.functional.silu(x)
def _sigmoid(x):
    return torch.sigmoid(x)
def _layernorm(x, axis=-1, eps=1e-5):
    m = x.mean(dim=axis, keepdim=True)
    v = x.var(dim=axis, keepdim=True, unbiased=False)
    return (x - m) / torch.sqrt(v + eps)
def _scatter_add(tgt, idx, src, axis=0):
    return tgt.clone().index_add_(axis, idx, src)
def _segment_sum(src, seg, n):
    out = torch.zeros((n,) + src.shape[1:], dtype=src.dtype)
    return out.index_add_(0, seg, src)
def _pad(x, pw):
    flat = tuple(v for pair in reversed(pw) for v in pair)
    return torch.nn.functional.pad(x, flat)

kernel_name = 'parallel_sum__sliding_block_cached__mixer_channel_mlp__decode'

def setup_inputs():

    _w = (lambda a: (lambda t: t.to(torch.bfloat16) if t.is_floating_point() else t)(torch.as_tensor(a)))
    def _A_setup():
        B, Sq, D = 1, 1, 1024
        Hq, Hkv, Sk, Dh = 32, 4, 65536, 128
        assert Hq % Hkv == 0, (Hq, Hkv)
        return {
            "x": _w((lambda *s: torch.randn(*s, dtype=torch.bfloat16) * 0.05)(B, Sq, D)),
            "k_cache": _w((lambda *s: torch.randn(*s, dtype=torch.bfloat16) * 3.2)(B, Hkv, Sk, Dh)),
            "v_cache": _w((lambda *s: torch.randn(*s, dtype=torch.bfloat16) * 0.4)(B, Hkv, Sk, Dh)),
            "wq": _w((lambda *s: torch.randn(*s, dtype=torch.bfloat16) * 3.2)(D, Hq * Dh) * (D ** -0.5)),
            "wo": _w((lambda *s: torch.randn(*s, dtype=torch.bfloat16) * 0.4)(Hq * Dh, D) * ((Hq * Dh) ** -0.5)),
        }
    _A_in = _A_setup()

    def _B_setup():
        B, S, D, F = 1, 1, 1024, 3584
        return {
            "x": _w((lambda *s: torch.randn(*s, dtype=torch.bfloat16) * 0.05)(B, S, D)),
            "w1": _w((lambda *s: torch.randn(*s, dtype=torch.bfloat16) * 1.6)(D, F) * (D ** -0.5)),
            "b1": _w((lambda *s: torch.randn(*s, dtype=torch.bfloat16) * 1.6)(F)),
            "w2": _w((lambda *s: torch.randn(*s, dtype=torch.bfloat16) * 0.1)(F, D) * (F ** -0.5)),
            "b2": _w((lambda *s: torch.randn(*s, dtype=torch.bfloat16) * 0.1)(D)),
        }
    _B_in = _B_setup()

    return {
        "A_x": _A_in["x"],
        "A_k_cache": _A_in["k_cache"],
        "A_v_cache": _A_in["v_cache"],
        "A_wq": _A_in["wq"],
        "A_wo": _A_in["wo"],
        "B_x": _B_in["x"],
        "B_w1": _B_in["w1"],
        "B_b1": _B_in["b1"],
        "B_w2": _B_in["w2"],
        "B_b2": _B_in["b2"],
    }

def reference(A_x, A_k_cache, A_v_cache, A_wq, A_wo, B_x, B_w1, B_b1, B_w2, B_b2):
    def _A_ref(x, k_cache, v_cache, wq, wo):
        B, Sq, D = x.shape
        Hq, Dh = 32, 128
        Hkv, Sk = k_cache.shape[1], k_cache.shape[2]
        W = min(4096, max(256, Sk // 4))
        rep = Hq // Hkv
        q = (lambda x, *d: x.permute(*d))((x @ wq).reshape(B, Sq, Hq, Dh), 0, 2, 1, 3)
        k = (lambda x, n, axis: torch.repeat_interleave(x, n, dim=axis))(k_cache[:, :, Sk - W:, :], rep, axis=1)
        v = (lambda x, n, axis: torch.repeat_interleave(x, n, dim=axis))(v_cache[:, :, Sk - W:, :], rep, axis=1)
        scores = torch.einsum("bhqd,bhkd->bhqk", q, k) * (Dh ** -0.5)
        p = _softmax(scores, axis=-1)
        o = torch.einsum("bhqk,bhkd->bhqd", p, v)
        return (lambda x, *d: x.permute(*d))(o, 0, 2, 1, 3).reshape(B, Sq, Hq * Dh) @ wo

    def _B_ref(x, w1, b1, w2, b2):
        y = _layernorm(x, axis=-1)
        h = _gelu(torch.einsum("bsd,df->bsf", y, w1) + b1)
        return torch.einsum("bsf,fd->bsd", h, w2) + b2

    x = A_x
    xn = _layernorm(x, axis=-1)
    return x + _A_ref(xn, A_k_cache, A_v_cache, A_wq, A_wo) + _B_ref(xn, B_w1, B_b1, B_w2, B_b2)
```

```asm
; @launch grid=(256,1,1) block=(576,1,1) lds=157696
.amdgcn_target "amdgcn-amd-amdhsa--gfx950"
.text
.globl parallel_sum__sliding_block_cached__mixer_channel_mlp__decode_kernel
.p2align 8
.type parallel_sum__sliding_block_cached__mixer_channel_mlp__decode_kernel,@function
parallel_sum__sliding_block_cached__mixer_channel_mlp__decode_kernel:
    s_cmp_ge_u32 s2, 256
    s_cbranch_scc1 L_exit
    s_load_dwordx16 s[4:19], s[0:1], 0
    s_load_dwordx8 s[20:27], s[0:1], 64
    s_load_dwordx2 s[28:29], s[0:1], 96
    v_and_b32 v1, 63, v0
    v_lshrrev_b32 v2, 6, v0
    s_lshr_b32 s32, s2, 4
    v_readfirstlane_b32 s30, v2
    s_and_b32 s31, s2, 7
    s_lshr_b32 s38, s2, 3
    s_lshl_b32 s38, s38, 4
    s_add_u32 s38, s38, s30
    s_cmp_lg_u32 s38, 488
    s_cbranch_scc1 L_nopf
    s_getpc_b64 s[50:51]
    v_lshlrev_b32 v7, 7, v1
    global_load_dword v30, v7, s[50:51]
    v_add_u32 v7, 8192, v7
    global_load_dword v31, v7, s[50:51]
L_nopf:
    s_lshr_b32 s33, s31, 1
    s_and_b32 s39, s31, 1
    v_lshrrev_b32 v3, 4, v1
    v_and_b32 v4, 15, v1
    s_lshl_b32 s34, s39, 4
    s_add_u32 s34, s34, s32
    s_lshr_b32 s35, s34, 2
    s_and_b32 s37, s34, 3
    s_xor_b32 s38, s33, 0
    s_lshl_b32 s38, s38, 2
    s_add_u32 s37, s37, s38
    s_lshl_b32 s38, s35, 7
    s_lshl_b32 s40, s30, 4
    s_add_u32 s38, s38, s40
    v_lshl_add_u32 v7, v3, 2, s38
    v_lshlrev_b32 v116, 13, v7
    v_lshlrev_b32 v121, 1, v7
    s_lshl_b32 s38, s37, 9
    v_lshl_add_u32 v116, v4, 4, v116
    v_add_u32 v116, s38, v116
    s_and_b32 s38, s30, 3
    s_lshl_b32 s38, s38, 9
    v_lshl_add_u32 v118, v1, 3, s38
    v_mov_b32 v68, 1048576
    v_xor_b32 v8, 512, v118
    v_xor_b32 v9, 1024, v118
    v_xor_b32 v10, 1536, v118
    s_bitcmp1_b32 s2, 3
    s_waitcnt lgkmcnt(0)
    s_cbranch_scc1 L_ent_l
    s_cmp_ge_u32 s30, 4
    s_cbranch_scc1 L_nox
    global_load_dwordx2 v[72:73], v118, s[4:5]
    global_load_dwordx2 v[74:75], v8, s[4:5]
    global_load_dwordx2 v[76:77], v9, s[4:5]
    global_load_dwordx2 v[78:79], v10, s[4:5]
L_nox:
    s_cmp_eq_u32 s30, 8
    s_barrier
    s_cbranch_scc1 L_nowq
    global_load_dword v68, v68, s[28:29] sc1
    global_load_dwordx4 v[28:31], v116, s[10:11] offset:0 nt
    global_load_dwordx4 v[32:35], v116, s[10:11] offset:256 nt
    v_add_u32 v116, 8192, v116
    global_load_dwordx4 v[36:39], v116, s[10:11] offset:0 nt
    global_load_dwordx4 v[40:43], v116, s[10:11] offset:256 nt
    v_add_u32 v116, 8192, v116
    global_load_dwordx4 v[44:47], v116, s[10:11] offset:0 nt
    s_branch L_nowq
L_ent_l:
    s_cmp_eq_u32 s30, 8
    s_cbranch_scc1 L_nowq
    global_load_dword v68, v68, s[28:29] sc1
L_nowq:
    v_mov_b32 v8, -1
    v_mov_b32 v9, -1
    v_mov_b32 v10, -1
    v_mov_b32 v11, -1
    v_lshlrev_b32 v7, 4, v0
    v_min_u32 v16, 7408, v7
    ds_write_b128 v7, v[8:11]
    ds_write_b128 v7, v[8:11] offset:9216
    ds_write_b128 v16, v[8:11] offset:18432
    v_mov_b32 v122, 25856
    v_mov_b32 v12, 0
    v_mov_b32 v13, 0
    v_mov_b32 v14, 0
    v_mov_b32 v15, 0
    v_mov_b32 v69, 1
    ds_write_b128 v122, v[12:15]
    ds_write_b128 v122, v[12:15] offset:16
    s_mov_b32 s36, 0x3f803f80
    v_lshrrev_b32 v5, 3, v1
    v_and_b32 v6, 7, v1
    s_lshl_b32 s38, s32, 1
    s_add_u32 s38, s38, s39
    s_and_b32 s54, s38, 3
    s_lshr_b32 s55, s38, 2
    s_mul_i32 s39, s33, 7
    s_add_u32 s55, s55, s39
    s_movk_i32 s66, 14
    s_cmp_eq_u32 s33, 3
    s_cselect_b32 s39, 0, 0
    s_sub_u32 s55, s55, s39
    s_cmp_ge_u32 s33, 2
    s_cmovk_i32 s66, 14
    s_lshr_b32 s56, s38, 3
    s_lshl_b32 s39, s33, 2
    s_add_u32 s56, s56, s39
    s_and_b32 s57, s38, 7
    s_add_u32 s64, s32, s31
    s_and_b32 s64, s64, 7
    s_lshr_b32 s42, s34, 2
    s_lshl_b32 s38, s33, 3
    s_add_u32 s42, s42, s38
    s_and_b32 s43, s34, 3
    s_cmp_eq_u32 s30, 8
    s_waitcnt lgkmcnt(0)
    s_barrier
    s_cbranch_scc1 L_loader
    s_sub_u32 s45, s30, s64
    s_and_b32 s45, s45, 7
    s_add_u32 s64, s45, 1
    v_and_b32 v7, 1, v4
    v_lshlrev_b32 v7, 4, v7
    v_mov_b32 v12, 0xffff
    v_lshlrev_b32 v7, v7, v12
    v_bfe_u32 v12, v4, 1, 2
    v_cmp_eq_u32 vcc, 0, v12
    s_nop 1
    v_cndmask_b32 v8, 0, v7, vcc
    v_cmp_eq_u32 vcc, 1, v12
    s_nop 1
    v_cndmask_b32 v9, 0, v7, vcc
    v_cmp_eq_u32 vcc, 2, v12
    s_nop 1
    v_cndmask_b32 v10, 0, v7, vcc
    v_cmp_eq_u32 vcc, 3, v12
    s_nop 1
    v_cndmask_b32 v11, 0, v7, vcc
    v_mov_b32 v20, 0
    v_mov_b32 v21, 0
    v_mov_b32 v22, 0
    v_mov_b32 v23, 0
    s_mov_b32 s47, 0x01000100
    s_mov_b32 s48, 0x03020302
    s_movk_i32 s52, 0xff
    s_lshl_b32 s38, s30, 9
    v_lshlrev_b32 v119, 5, v4
    v_lshl_add_u32 v119, v3, 4, v119
    v_add_u32 v119, s38, v119
    v_lshrrev_b32 v7, 5, v1
    v_lshlrev_b32 v120, 11, v7
    v_and_b32 v7, 31, v1
    v_lshl_add_u32 v120, v7, 4, v120
    v_mov_b32 v24, 0
    v_mov_b32 v25, 0
    v_mov_b32 v26, 0
    v_mov_b32 v27, 0
    s_bitcmp1_b32 s2, 3
    s_cbranch_scc1 L_lworker
    s_cmp_ge_u32 s30, 4
    s_cbranch_scc1 L_noln
    s_waitcnt vmcnt(6)
    v_lshlrev_b32 v80, 16, v72
    v_and_b32 v81, 0xffff0000, v72
    v_lshlrev_b32 v82, 16, v73
    v_and_b32 v83, 0xffff0000, v73
    v_readfirstlane_b32 s44, v80
    v_lshlrev_b32 v88, 16, v74
    v_and_b32 v89, 0xffff0000, v74
    v_lshlrev_b32 v90, 16, v75
    v_and_b32 v91, 0xffff0000, v75
    v_lshlrev_b32 v92, 16, v76
    v_and_b32 v93, 0xffff0000, v76
    v_lshlrev_b32 v94, 16, v77
    v_and_b32 v95, 0xffff0000, v77
    v_lshlrev_b32 v96, 16, v78
    v_and_b32 v97, 0xffff0000, v78
    v_lshlrev_b32 v98, 16, v79
    v_and_b32 v99, 0xffff0000, v79
    v_subrev_f32 v84, s44, v80
    v_subrev_f32 v85, s44, v81
    v_subrev_f32 v86, s44, v82
    v_subrev_f32 v87, s44, v83
    v_subrev_f32 v88, s44, v88
    v_subrev_f32 v89, s44, v89
    v_subrev_f32 v90, s44, v90
    v_subrev_f32 v91, s44, v91
    v_subrev_f32 v92, s44, v92
    v_subrev_f32 v93, s44, v93
    v_subrev_f32 v94, s44, v94
    v_subrev_f32 v95, s44, v95
    v_subrev_f32 v96, s44, v96
    v_subrev_f32 v97, s44, v97
    v_subrev_f32 v98, s44, v98
    v_subrev_f32 v99, s44, v99
    v_pk_mul_f32 v[102:103], v[84:85], v[84:85]
    v_pk_add_f32 v[100:101], v[84:85], v[86:87]
    v_pk_fma_f32 v[102:103], v[86:87], v[86:87], v[102:103]
    v_pk_fma_f32 v[102:103], v[88:89], v[88:89], v[102:103]
    v_pk_add_f32 v[100:101], v[100:101], v[88:89]
    v_pk_fma_f32 v[102:103], v[90:91], v[90:91], v[102:103]
    v_pk_add_f32 v[100:101], v[100:101], v[90:91]
    v_pk_fma_f32 v[102:103], v[92:93], v[92:93], v[102:103]
    v_pk_add_f32 v[100:101], v[100:101], v[92:93]
    v_pk_fma_f32 v[102:103], v[94:95], v[94:95], v[102:103]
    v_pk_add_f32 v[100:101], v[100:101], v[94:95]
    v_pk_fma_f32 v[102:103], v[96:97], v[96:97], v[102:103]
    v_pk_add_f32 v[100:101], v[100:101], v[96:97]
    v_pk_fma_f32 v[102:103], v[98:99], v[98:99], v[102:103]
    v_pk_add_f32 v[100:101], v[100:101], v[98:99]
    v_add_f32 v100, v100, v101
    v_add_f32 v102, v102, v103
    s_nop 0
    v_add_f32_dpp v100, v100, v100 row_ror:8 row_mask:0xf bank_mask:0xf
    v_add_f32_dpp v102, v102, v102 row_ror:8 row_mask:0xf bank_mask:0xf
    s_nop 0
    v_add_f32_dpp v100, v100, v100 row_ror:4 row_mask:0xf bank_mask:0xf
    v_add_f32_dpp v102, v102, v102 row_ror:4 row_mask:0xf bank_mask:0xf
    s_nop 0
    v_add_f32_dpp v100, v100, v100 row_ror:2 row_mask:0xf bank_mask:0xf
    v_add_f32_dpp v102, v102, v102 row_ror:2 row_mask:0xf bank_mask:0xf
    s_nop 0
    v_add_f32_dpp v100, v100, v100 row_ror:1 row_mask:0xf bank_mask:0xf
    v_add_f32_dpp v102, v102, v102 row_ror:1 row_mask:0xf bank_mask:0xf
    s_nop 0
    v_add_f32_dpp v100, v100, v100 row_bcast:15 row_mask:0xa bank_mask:0xf
    v_add_f32_dpp v102, v102, v102 row_bcast:15 row_mask:0xa bank_mask:0xf
    s_nop 0
    v_add_f32_dpp v100, v100, v100 row_bcast:31 row_mask:0xc bank_mask:0xf
    v_add_f32_dpp v102, v102, v102 row_bcast:31 row_mask:0xc bank_mask:0xf
    s_nop 0
    v_readlane_b32 s40, v100, 63
    v_readlane_b32 s41, v102, 63
    s_nop 0
    v_mov_b32 v100, s40
    v_mov_b32 v102, s41
    v_mul_f32 v100, 0x3a800000, v100
    v_mul_f32 v102, 0x3a800000, v102
    v_fma_f32 v102, -v100, v100, v102
    v_add_f32 v100, s44, v100
    v_max_f32 v102, 0, v102
    v_cvt_pk_bf16_f32 v101, v100, v102
    v_and_b32 v102, 0xffff0000, v101
    v_lshlrev_b32 v100, 16, v101
    v_add_f32 v102, 0x3727c5ac, v102
    v_cvt_pk_bf16_f32 v101, v102, v102
    v_and_b32 v102, 0xffff0000, v101
    v_sqrt_f32 v102, v102
    v_sub_f32 v80, v80, v100
    v_sub_f32 v81, v81, v100
    v_cvt_pk_bf16_f32 v101, v102, v102
    v_and_b32 v102, 0xffff0000, v101
    v_rcp_f32 v103, v102
    v_sub_f32 v82, v82, v100
    v_sub_f32 v83, v83, v100
    v_cvt_pk_bf16_f32 v100, v80, v81
    v_cvt_pk_bf16_f32 v101, v82, v83
    v_lshlrev_b32 v80, 16, v100
    v_and_b32 v81, 0xffff0000, v100
    v_lshlrev_b32 v82, 16, v101
    v_and_b32 v83, 0xffff0000, v101
    v_mul_f32 v84, v80, v103
    v_mul_f32 v85, v81, v103
    v_mul_f32 v86, v82, v103
    v_mul_f32 v87, v83, v103
    v_fma_f32 v80, -v84, v102, v80
    v_fma_f32 v81, -v85, v102, v81
    v_fma_f32 v82, -v86, v102, v82
    v_fma_f32 v83, -v87, v102, v83
    v_fma_f32 v84, v80, v103, v84
    v_fma_f32 v85, v81, v103, v85
    v_fma_f32 v86, v82, v103, v86
    v_fma_f32 v87, v83, v103, v87
    v_cvt_pk_bf16_f32 v100, v84, v85
    v_cvt_pk_bf16_f32 v101, v86, v87
    ds_write_b64 v118, v[100:101] offset:3328
    s_branch L_ln_done
L_noln:
    s_sleep 8
L_ln_done:
    s_mov_b32 s49, 0
L_sp_1:
    ds_read_b64 v[100:101], v121 offset:3328
    s_add_u32 s49, s49, 1
    s_waitcnt lgkmcnt(0)
    v_max_u32 v84, v100, v101
    v_cmp_eq_u32 vcc, -1, v84
    s_cmp_gt_u32 s49, 800000
    s_cbranch_scc1 L_sd_2
    s_cbranch_vccz L_sd_2
    s_sleep 1
    s_branch L_sp_1
L_sd_2:
    v_perm_b32 v60, v100, v100, s47
    v_perm_b32 v61, v100, v100, s48
    v_perm_b32 v62, v101, v101, s47
    v_perm_b32 v63, v101, v101, s48
    v_and_b32 v12, v8, v60
    v_and_b32 v13, v9, v60
    v_and_b32 v14, v10, v60
    v_and_b32 v15, v11, v60
    s_waitcnt vmcnt(4)
    global_load_dwordx4 v[48:51], v116, s[10:11] offset:256 nt
    v_add_u32 v116, 8192, v116
    v_mfma_f32_16x16x32_bf16 v[20:23], v[12:15], v[28:31], v[20:23]
    s_waitcnt vmcnt(4)
    global_load_dwordx4 v[52:55], v116, s[10:11] offset:0 nt
    v_mfma_f32_16x16x32_bf16 v[24:27], v[12:15], v[32:35], v[24:27]
    v_and_b32 v16, v8, v61
    v_and_b32 v17, v9, v61
    v_and_b32 v18, v10, v61
    v_and_b32 v19, v11, v61
    s_waitcnt vmcnt(4)
    global_load_dwordx4 v[56:59], v116, s[10:11] offset:256 nt
    v_mfma_f32_16x16x32_bf16 v[20:23], v[16:19], v[36:39], v[20:23]
    s_waitcnt vmcnt(4)
    s_nop 0
    v_mfma_f32_16x16x32_bf16 v[24:27], v[16:19], v[40:43], v[24:27]
    v_and_b32 v12, v8, v62
    v_and_b32 v13, v9, v62
    v_and_b32 v14, v10, v62
    v_and_b32 v15, v11, v62
    s_waitcnt vmcnt(3)
    s_nop 0
    v_mfma_f32_16x16x32_bf16 v[20:23], v[12:15], v[44:47], v[20:23]
    s_waitcnt vmcnt(2)
    s_nop 0
    v_mfma_f32_16x16x32_bf16 v[24:27], v[12:15], v[48:51], v[24:27]
    v_and_b32 v16, v8, v63
    v_and_b32 v17, v9, v63
    v_and_b32 v18, v10, v63
    v_and_b32 v19, v11, v63
    s_waitcnt vmcnt(1)
    s_nop 0
    v_mfma_f32_16x16x32_bf16 v[20:23], v[16:19], v[52:55], v[20:23]
    s_waitcnt vmcnt(0)
    s_nop 0
    v_mfma_f32_16x16x32_bf16 v[24:27], v[16:19], v[56:59], v[24:27]
    v_add_u32 v68, 1, v68
    v_and_b32 v68, 0xfff, v68
    v_mov_b32 v7, 1
    s_mov_b64 exec, 1
    ds_add_u32 v122, v7 offset:4
    s_mov_b64 exec, 0xffffffff
    s_nop 2
    ds_write_b128 v119, v[20:23] offset:5376
    ds_write_b128 v119, v[24:27] offset:9472
    s_mov_b64 exec, -1
    s_cmp_lg_u32 s30, 0
    s_cbranch_scc1 L_rp_3
    s_lshl_b32 s38, s35, 14
    s_lshl_b32 s39, s37, 10
    s_add_u32 s38, s38, s39
    s_add_u32 s38, s38, 0
    v_and_b32 v7, 31, v1
    v_lshl_add_u32 v7, v7, 4, s38
    s_movk_i32 s38, 63
    s_mov_b32 s49, 0
L_sp_4:
    ds_read_b128 v[100:103], v120 offset:5376
    ds_read_b128 v[104:107], v120 offset:5888
    ds_read_b128 v[108:111], v120 offset:6400
    ds_read_b128 v[112:115], v120 offset:6912
    s_add_u32 s49, s49, 1
    s_waitcnt lgkmcnt(0)
    v_max3_u32 v84, v100, v103, v104
    v_max3_u32 v85, v107, v108, v111
    v_max3_u32 v84, v84, v112, v115
    v_max_u32 v84, v84, v85
    v_cmp_eq_u32 vcc, -1, v84
    s_cmp_gt_u32 s49, 800000
    s_cbranch_scc1 L_sd_5
    s_cbranch_vccnz L_sp_4
L_sd_5:
    v_pk_add_f32 v[100:101], v[100:101], v[104:105]
    v_pk_add_f32 v[102:103], v[102:103], v[106:107]
    v_pk_add_f32 v[108:109], v[108:109], v[112:113]
    v_pk_add_f32 v[110:111], v[110:111], v[114:115]
    v_pk_add_f32 v[100:101], v[100:101], v[108:109]
    v_pk_add_f32 v[102:103], v[102:103], v[110:111]
    v_mov_b32 v104, v100
    v_mov_b32 v105, v101
    v_mov_b32 v106, v102
    v_mov_b32 v107, v103
    s_nop 0
    v_permlane32_swap_b32 v100, v104
    v_permlane32_swap_b32 v101, v105
    v_permlane32_swap_b32 v102, v106
    v_permlane32_swap_b32 v103, v107
    v_pk_add_f32 v[100:101], v[100:101], v[104:105]
    v_pk_add_f32 v[102:103], v[102:103], v[106:107]
    v_add_u32 v100, 32, v100
    v_add_u32 v101, 32, v101
    v_add_u32 v102, 32, v102
    v_add_u32 v103, 32, v103
    v_bfi_b32 v100, s38, v68, v100
    v_bfi_b32 v101, s38, v68, v101
    v_bfi_b32 v102, s38, v68, v102
    v_bfi_b32 v103, s38, v68, v103
    s_mov_b64 exec, 0xffffffff
    global_store_dwordx4 v7, v[100:103], s[28:29] sc1
    s_mov_b64 exec, -1
L_rp_3:
    s_cmp_lg_u32 s30, 1
    s_cbranch_scc1 L_rp_6
    s_lshl_b32 s38, s35, 14
    s_lshl_b32 s39, s37, 10
    s_add_u32 s38, s38, s39
    s_add_u32 s38, s38, 0
    s_add_u32 s38, s38, 512
    v_and_b32 v7, 31, v1
    v_lshl_add_u32 v7, v7, 4, s38
    s_movk_i32 s38, 63
    s_mov_b32 s49, 0
L_sp_7:
    ds_read_b128 v[100:103], v120 offset:9472
    ds_read_b128 v[104:107], v120 offset:9984
    ds_read_b128 v[108:111], v120 offset:10496
    ds_read_b128 v[112:115], v120 offset:11008
    s_add_u32 s49, s49, 1
    s_waitcnt lgkmcnt(0)
    v_max3_u32 v84, v100, v103, v104
    v_max3_u32 v85, v107, v108, v111
    v_max3_u32 v84, v84, v112, v115
    v_max_u32 v84, v84, v85
    v_cmp_eq_u32 vcc, -1, v84
    s_cmp_gt_u32 s49, 800000
    s_cbranch_scc1 L_sd_8
    s_cbranch_vccnz L_sp_7
L_sd_8:
    v_pk_add_f32 v[100:101], v[100:101], v[104:105]
    v_pk_add_f32 v[102:103], v[102:103], v[106:107]
    v_pk_add_f32 v[108:109], v[108:109], v[112:113]
    v_pk_add_f32 v[110:111], v[110:111], v[114:115]
    v_pk_add_f32 v[100:101], v[100:101], v[108:109]
    v_pk_add_f32 v[102:103], v[102:103], v[110:111]
    v_mov_b32 v104, v100
    v_mov_b32 v105, v101
    v_mov_b32 v106, v102
    v_mov_b32 v107, v103
    s_nop 0
    v_permlane32_swap_b32 v100, v104
    v_permlane32_swap_b32 v101, v105
    v_permlane32_swap_b32 v102, v106
    v_permlane32_swap_b32 v103, v107
    v_pk_add_f32 v[100:101], v[100:101], v[104:105]
    v_pk_add_f32 v[102:103], v[102:103], v[106:107]
    v_add_u32 v100, 32, v100
    v_add_u32 v101, 32, v101
    v_add_u32 v102, 32, v102
    v_add_u32 v103, 32, v103
    v_bfi_b32 v100, s38, v68, v100
    v_bfi_b32 v101, s38, v68, v101
    v_bfi_b32 v102, s38, v68, v102
    v_bfi_b32 v103, s38, v68, v103
    s_mov_b64 exec, 0xffffffff
    global_store_dwordx4 v7, v[100:103], s[28:29] sc1
    s_mov_b64 exec, -1
L_rp_6:
    v_mov_b32 v20, 0
    v_mov_b32 v21, 0
    v_mov_b32 v22, 0
    v_mov_b32 v23, 0
    s_mul_i32 s38, s56, 224
    s_mul_i32 s39, s30, 28
    s_add_u32 s58, s38, s39
    v_add_u32 v7, s58, v3
    v_min_u32 v100, 6, v6
    s_movk_i32 s38, 14336
    v_mul_lo_u32 v117, v3, s38
    v_lshl_add_u32 v117, v100, 4, v117
    s_lshl_b32 s38, s58, 2
    s_add_u32 s38, s38, 131072
    v_add_u32 v117, s38, v117
    v_lshl_add_u32 v100, v100, 2, v7
    v_lshlrev_b32 v127, 1, v100
    global_load_ushort v124, v127, s[18:19]
    s_mov_b32 s53, 0
    s_cmp_ge_u32 s32, s66
    s_cbranch_scc1 L_e_now1
    s_movk_i32 s53, 64
    s_cmp_lt_u32 s30, 4
    s_cbranch_scc1 L_e_noln2
    v_xor_b32 v100, 512, v118
    v_xor_b32 v101, 1024, v118
    v_xor_b32 v102, 1536, v118
    s_mov_b32 s49, 0
L_sp_9:
    ds_read_b64 v[72:73], v118 offset:3328
    ds_read_b64 v[74:75], v100 offset:3328
    ds_read_b64 v[76:77], v101 offset:3328
    ds_read_b64 v[78:79], v102 offset:3328
    s_add_u32 s49, s49, 1
    s_waitcnt lgkmcnt(0)
    v_max3_u32 v84, v72, v73, v74
    v_max3_u32 v85, v75, v76, v77
    v_max3_u32 v84, v84, v78, v79
    v_max_u32 v84, v84, v85
    v_cmp_eq_u32 vcc, -1, v84
    s_cmp_gt_u32 s49, 800000
    s_cbranch_scc1 L_sd_10
    s_cbranch_vccnz L_sp_9
L_sd_10:
    v_lshlrev_b32 v80, 16, v72
    v_and_b32 v81, 0xffff0000, v72
    v_lshlrev_b32 v82, 16, v73
    v_and_b32 v83, 0xffff0000, v73
    s_mov_b32 s44, 0
    v_mov_b32 v100, 0
    v_mov_b32 v101, 0
    v_mov_b32 v102, 0
    v_mov_b32 v103, 0
    v_dot2_f32_bf16 v100, v72, s36, v100
    v_dot2_f32_bf16 v102, v72, v72, v102
    v_dot2_f32_bf16 v101, v73, s36, v101
    v_dot2_f32_bf16 v103, v73, v73, v103
    v_dot2_f32_bf16 v100, v74, s36, v100
    v_dot2_f32_bf16 v102, v74, v74, v102
    v_dot2_f32_bf16 v101, v75, s36, v101
    v_dot2_f32_bf16 v103, v75, v75, v103
    v_dot2_f32_bf16 v100, v76, s36, v100
    v_dot2_f32_bf16 v102, v76, v76, v102
    v_dot2_f32_bf16 v101, v77, s36, v101
    v_dot2_f32_bf16 v103, v77, v77, v103
    v_dot2_f32_bf16 v100, v78, s36, v100
    v_dot2_f32_bf16 v102, v78, v78, v102
    v_dot2_f32_bf16 v101, v79, s36, v101
    v_dot2_f32_bf16 v103, v79, v79, v103
    s_nop 2
    v_add_f32 v100, v100, v101
    v_add_f32 v102, v102, v103
    s_nop 0
    v_add_f32_dpp v100, v100, v100 row_ror:8 row_mask:0xf bank_mask:0xf
    v_add_f32_dpp v102, v102, v102 row_ror:8 row_mask:0xf bank_mask:0xf
    s_nop 0
    v_add_f32_dpp v100, v100, v100 row_ror:4 row_mask:0xf bank_mask:0xf
    v_add_f32_dpp v102, v102, v102 row_ror:4 row_mask:0xf bank_mask:0xf
    s_nop 0
    v_add_f32_dpp v100, v100, v100 row_ror:2 row_mask:0xf bank_mask:0xf
    v_add_f32_dpp v102, v102, v102 row_ror:2 row_mask:0xf bank_mask:0xf
    s_nop 0
    v_add_f32_dpp v100, v100, v100 row_ror:1 row_mask:0xf bank_mask:0xf
    v_add_f32_dpp v102, v102, v102 row_ror:1 row_mask:0xf bank_mask:0xf
    s_nop 0
    v_add_f32_dpp v100, v100, v100 row_bcast:15 row_mask:0xa bank_mask:0xf
    v_add_f32_dpp v102, v102, v102 row_bcast:15 row_mask:0xa bank_mask:0xf
    s_nop 0
    v_add_f32_dpp v100, v100, v100 row_bcast:31 row_mask:0xc bank_mask:0xf
    v_add_f32_dpp v102, v102, v102 row_bcast:31 row_mask:0xc bank_mask:0xf
    s_nop 0
    v_readlane_b32 s40, v100, 63
    v_readlane_b32 s41, v102, 63
    s_nop 0
    v_mov_b32 v100, s40
    v_mov_b32 v102, s41
    v_mul_f32 v100, 0x3a800000, v100
    v_mul_f32 v102, 0x3a800000, v102
    v_fma_f32 v102, -v100, v100, v102
    v_add_f32 v100, s44, v100
    v_max_f32 v102, 0, v102
    v_cvt_pk_bf16_f32 v101, v100, v102
    v_and_b32 v102, 0xffff0000, v101
    v_lshlrev_b32 v100, 16, v101
    v_add_f32 v102, 0x3727c5ac, v102
    v_cvt_pk_bf16_f32 v101, v102, v102
    v_and_b32 v102, 0xffff0000, v101
    v_sqrt_f32 v102, v102
    v_sub_f32 v80, v80, v100
    v_sub_f32 v81, v81, v100
    v_cvt_pk_bf16_f32 v101, v102, v102
    v_and_b32 v102, 0xffff0000, v101
    v_rcp_f32 v103, v102
    v_sub_f32 v82, v82, v100
    v_sub_f32 v83, v83, v100
    v_cvt_pk_bf16_f32 v100, v80, v81
    v_cvt_pk_bf16_f32 v101, v82, v83
    v_lshlrev_b32 v80, 16, v100
    v_and_b32 v81, 0xffff0000, v100
    v_lshlrev_b32 v82, 16, v101
    v_and_b32 v83, 0xffff0000, v101
    v_mul_f32 v84, v80, v103
    v_mul_f32 v85, v81, v103
    v_mul_f32 v86, v82, v103
    v_mul_f32 v87, v83, v103
    v_fma_f32 v80, -v84, v102, v80
    v_fma_f32 v81, -v85, v102, v81
    v_fma_f32 v82, -v86, v102, v82
    v_fma_f32 v83, -v87, v102, v83
    v_fma_f32 v84, v80, v103, v84
    v_fma_f32 v85, v81, v103, v85
    v_fma_f32 v86, v82, v103, v86
    v_fma_f32 v87, v83, v103, v87
    v_cvt_pk_bf16_f32 v100, v84, v85
    v_cvt_pk_bf16_f32 v101, v86, v87
    ds_write_b64 v118, v[100:101] offset:13568
L_e_noln2:
    s_lshl_b32 s38, s54, 8
    s_lshl_b32 s39, s30, 5
    s_add_u32 s38, s38, s39
    v_lshl_add_u32 v7, v3, 3, s38
    v_lshlrev_b32 v7, 1, v7
    s_lshl_b32 s38, s30, 13
    s_add_u32 s38, s38, 26624
    v_lshl_add_u32 v123, v1, 4, s38
    s_lshl_b32 s50, s64, 3
    s_mov_b32 s49, 0
L_sp_11:
    ds_read_b128 v[100:103], v7 offset:13568
    s_add_u32 s49, s49, 1
    s_waitcnt lgkmcnt(0)
    v_max3_u32 v84, v100, v101, v102
    v_max_u32 v84, v84, v103
    v_cmp_eq_u32 vcc, -1, v84
    s_cmp_gt_u32 s49, 800000
    s_cbranch_scc1 L_sd_12
    s_cbranch_vccz L_sd_12
    s_sleep 2
    s_branch L_sp_11
L_sd_12:
    v_perm_b32 v60, v100, v100, s47
    v_perm_b32 v61, v100, v100, s48
    v_perm_b32 v62, v101, v101, s47
    v_perm_b32 v63, v101, v101, s48
    v_perm_b32 v64, v102, v102, s47
    v_perm_b32 v65, v102, v102, s48
    v_perm_b32 v66, v103, v103, s47
    v_perm_b32 v67, v103, v103, s48
    s_mov_b32 s49, 0
L_wp_13:
    ds_read_b32 v100, v122
    s_add_u32 s49, s49, 1
    s_waitcnt lgkmcnt(0)
    v_readfirstlane_b32 s51, v100
    s_cmp_ge_i32 s51, s50
    s_cbranch_scc1 L_wd_14
    s_cmp_gt_u32 s49, 800000
    s_cbranch_scc1 L_wd_14
    s_sleep 1
    s_branch L_wp_13
L_wd_14:
    ds_read_b128 v[28:31], v123 offset:0
    ds_read_b128 v[32:35], v123 offset:1024
    ds_read_b128 v[36:39], v123 offset:2048
    ds_read_b128 v[40:43], v123 offset:3072
    ds_read_b128 v[44:47], v123 offset:4096
    ds_read_b128 v[48:51], v123 offset:5120
    ds_read_b128 v[52:55], v123 offset:6144
    ds_read_b128 v[56:59], v123 offset:7168
    v_and_b32 v12, v8, v60
    v_and_b32 v13, v9, v60
    v_and_b32 v14, v10, v60
    v_and_b32 v15, v11, v60
    s_waitcnt lgkmcnt(7)
    s_nop 0
    v_mfma_f32_16x16x32_bf16 v[20:23], v[12:15], v[28:31], v[20:23]
    v_and_b32 v16, v8, v61
    v_and_b32 v17, v9, v61
    v_and_b32 v18, v10, v61
    v_and_b32 v19, v11, v61
    s_waitcnt lgkmcnt(6)
    s_nop 0
    v_mfma_f32_16x16x32_bf16 v[20:23], v[16:19], v[32:35], v[20:23]
    v_and_b32 v12, v8, v62
    v_and_b32 v13, v9, v62
    v_and_b32 v14, v10, v62
    v_and_b32 v15, v11, v62
    s_waitcnt lgkmcnt(5)
    s_nop 0
    v_mfma_f32_16x16x32_bf16 v[20:23], v[12:15], v[36:39], v[20:23]
    v_and_b32 v16, v8, v63
    v_and_b32 v17, v9, v63
    v_and_b32 v18, v10, v63
    v_and_b32 v19, v11, v63
    s_waitcnt lgkmcnt(4)
    s_nop 0
    v_mfma_f32_16x16x32_bf16 v[20:23], v[16:19], v[40:43], v[20:23]
    v_and_b32 v12, v8, v64
    v_and_b32 v13, v9, v64
    v_and_b32 v14, v10, v64
    v_and_b32 v15, v11, v64
    s_waitcnt lgkmcnt(3)
    s_nop 0
    v_mfma_f32_16x16x32_bf16 v[20:23], v[12:15], v[44:47], v[20:23]
    v_and_b32 v16, v8, v65
    v_and_b32 v17, v9, v65
    v_and_b32 v18, v10, v65
    v_and_b32 v19, v11, v65
    s_waitcnt lgkmcnt(2)
    s_nop 0
    v_mfma_f32_16x16x32_bf16 v[20:23], v[16:19], v[48:51], v[20:23]
    v_and_b32 v12, v8, v66
    v_and_b32 v13, v9, v66
    v_and_b32 v14, v10, v66
    v_and_b32 v15, v11, v66
    s_waitcnt lgkmcnt(1)
    s_nop 0
    v_mfma_f32_16x16x32_bf16 v[20:23], v[12:15], v[52:55], v[20:23]
    v_and_b32 v16, v8, v67
    v_and_b32 v17, v9, v67
    v_and_b32 v18, v10, v67
    v_and_b32 v19, v11, v67
    s_waitcnt lgkmcnt(0)
    s_nop 0
    v_mfma_f32_16x16x32_bf16 v[20:23], v[16:19], v[56:59], v[20:23]
    s_nop 7
    s_mov_b64 exec, 0xffffffff
    ds_write_b128 v119, v[20:23] offset:17664
    s_mov_b64 exec, -1
    s_cmp_lg_u32 s64, 8
    s_cbranch_scc1 L_rp_15
    s_mul_i32 s38, s54, 14336
    s_lshl_b32 s39, s55, 9
    s_add_u32 s38, s38, s39
    s_add_u32 s38, s38, 131072
    v_and_b32 v7, 31, v1
    v_lshl_add_u32 v7, v7, 4, s38
    s_movk_i32 s38, 255
    s_mov_b32 s49, 0
L_sp_16:
    ds_read_b128 v[100:103], v120 offset:17664
    ds_read_b128 v[104:107], v120 offset:18176
    ds_read_b128 v[108:111], v120 offset:18688
    ds_read_b128 v[112:115], v120 offset:19200
    s_add_u32 s49, s49, 1
    s_waitcnt lgkmcnt(0)
    v_max3_u32 v84, v100, v103, v104
    v_max3_u32 v85, v107, v108, v111
    v_max3_u32 v84, v84, v112, v115
    v_max_u32 v84, v84, v85
    v_cmp_eq_u32 vcc, -1, v84
    s_cmp_gt_u32 s49, 800000
    s_cbranch_scc1 L_sd_17
    s_cbranch_vccnz L_sp_16
L_sd_17:
    v_pk_add_f32 v[100:101], v[100:101], v[104:105]
    v_pk_add_f32 v[102:103], v[102:103], v[106:107]
    v_pk_add_f32 v[108:109], v[108:109], v[112:113]
    v_pk_add_f32 v[110:111], v[110:111], v[114:115]
    v_pk_add_f32 v[100:101], v[100:101], v[108:109]
    v_pk_add_f32 v[102:103], v[102:103], v[110:111]
    v_mov_b32 v104, v100
    v_mov_b32 v105, v101
    v_mov_b32 v106, v102
    v_mov_b32 v107, v103
    s_nop 0
    v_permlane32_swap_b32 v100, v104
    v_permlane32_swap_b32 v101, v105
    v_permlane32_swap_b32 v102, v106
    v_permlane32_swap_b32 v103, v107
    v_pk_add_f32 v[100:101], v[100:101], v[104:105]
    v_pk_add_f32 v[102:103], v[102:103], v[106:107]
    v_add_u32 v100, 128, v100
    v_add_u32 v101, 128, v101
    v_add_u32 v102, 128, v102
    v_add_u32 v103, 128, v103
    v_bfi_b32 v100, s38, v68, v100
    v_bfi_b32 v101, s38, v68, v101
    v_bfi_b32 v102, s38, v68, v102
    v_bfi_b32 v103, s38, v68, v103
    s_mov_b64 exec, 0xffffffff
    global_store_dwordx4 v7, v[100:103], s[28:29] sc1
    s_mov_b64 exec, -1
L_rp_15:
    v_mov_b32 v20, 0
    v_mov_b32 v21, 0
    v_mov_b32 v22, 0
    v_mov_b32 v23, 0
L_e_now1:
    s_lshl_b32 s38, s30, 9
    v_lshlrev_b32 v119, 5, v4
    v_lshl_add_u32 v119, v3, 4, v119
    v_add_u32 v119, s38, v119
    v_and_b32 v108, 3, v1
    v_bfe_u32 v120, v1, 2, 3
    v_lshlrev_b32 v120, 9, v120
    v_lshl_add_u32 v120, v108, 4, v120
    s_lshl_b32 s38, s30, 6
    v_add_u32 v120, s38, v120
    s_lshl_b32 s38, s57, 3
    s_add_u32 s38, s38, s30
    s_mul_i32 s38, s38, 3072
    s_lshl_b32 s40, s56, 6
    s_add_u32 s38, s38, s40
    s_add_u32 s38, s38, 262144
    v_lshl_add_u32 v109, v108, 4, s38
    s_mov_b32 s40, 0xbdd2d3e8
    s_mov_b32 s41, 0xc0135761
    v_mov_b32 v110, s41
    s_mul_i32 s38, s30, 7168
    s_add_u32 s38, s38, 92160
    v_lshl_add_u32 v123, v1, 4, s38
    s_add_u32 s50, s53, 44
    s_mov_b32 s39, 0
    s_mov_b32 s49, 0
L_wp_18:
    ds_read_b32 v100, v122
    s_add_u32 s49, s49, 1
    s_waitcnt lgkmcnt(0)
    v_readfirstlane_b32 s51, v100
    s_cmp_ge_i32 s51, s50
    s_cbranch_scc1 L_wd_19
    s_cmp_gt_u32 s49, 800000
    s_cbranch_scc1 L_wd_19
    s_sleep 1
    s_branch L_wp_18
L_wd_19:
L_e_h:
    global_load_dwordx4 v[84:87], v117, s[28:29] sc1
    s_add_u32 s39, s39, 1
    s_waitcnt vmcnt(0)
    v_bitop3_b32 v100, v84, v85, v68 bitop3:0x7e
    v_bitop3_b32 v101, v86, v87, v68 bitop3:0x7e
    v_or_b32 v100, v100, v101
    v_and_b32 v100, s52, v100
    v_cmp_ne_u32 vcc, 0, v100
    s_cmp_gt_u32 s39, 200000
    s_cbranch_scc1 L_e_hdn
    s_cbranch_vccz L_e_hdn
    s_sleep 16
    s_branch L_e_h
L_e_hdn:
    s_mul_i32 s50, s64, 7
    s_add_u32 s50, s50, s53
    ds_read_b32 v111, v122
    ds_read_b128 v[28:31], v123 offset:0
    ds_read_b128 v[32:35], v123 offset:1024
    ds_read_b128 v[36:39], v123 offset:2048
    ds_read_b128 v[40:43], v123 offset:3072
    ds_read_b128 v[44:47], v123 offset:4096
    ds_read_b128 v[48:51], v123 offset:5120
    ds_read_b128 v[52:55], v123 offset:6144
    v_and_b32 v84, 0xffffff00, v84
    v_and_b32 v85, 0xffffff00, v85
    v_and_b32 v86, 0xffffff00, v86
    v_and_b32 v87, 0xffffff00, v87
    s_nop 1
    v_permlane32_swap_b32 v84, v86
    v_permlane32_swap_b32 v85, v87
    v_add_f32 v84, v84, v86
    v_add_f32 v85, v85, v87
    v_lshlrev_b32 v124, 16, v124
    s_nop 0
    v_permlane16_swap_b32 v84, v85
    v_add_f32 v84, v84, v85
    v_cvt_pk_bf16_f32 v100, v84, v84
    v_and_b32 v84, 0xffff0000, v100
    v_add_f32 v84, v84, v124
    v_cvt_pk_bf16_f32 v100, v84, v84
    v_and_b32 v84, 0xffff0000, v100
    v_mul_f32 v100, v84, v84
    v_fma_f32 v100, v100, s40, v110
    v_mul_f32 v100, v100, v84
    v_exp_f32 v100, v100
    s_nop 0
    v_add_f32 v100, 1.0, v100
    v_rcp_f32 v100, v100
    s_nop 0
    v_mul_f32 v84, v84, v100
    v_cvt_pk_bf16_f32 v84, v84, v84
    s_nop 1
    v_mov_b32_dpp v60, v84 row_newbcast:0 row_mask:0xf bank_mask:0xf
    v_mov_b32_dpp v61, v84 row_newbcast:1 row_mask:0xf bank_mask:0xf
    v_mov_b32_dpp v62, v84 row_newbcast:2 row_mask:0xf bank_mask:0xf
    v_mov_b32_dpp v63, v84 row_newbcast:3 row_mask:0xf bank_mask:0xf
    v_mov_b32_dpp v64, v84 row_newbcast:4 row_mask:0xf bank_mask:0xf
    v_mov_b32_dpp v65, v84 row_newbcast:5 row_mask:0xf bank_mask:0xf
    v_mov_b32_dpp v66, v84 row_newbcast:6 row_mask:0xf bank_mask:0xf
    s_waitcnt lgkmcnt(0)
    v_readfirstlane_b32 s51, v111
    s_cmp_ge_i32 s51, s50
    s_cbranch_scc1 L_e_wok
    s_mov_b32 s49, 0
L_wp_20:
    ds_read_b32 v100, v122
    s_add_u32 s49, s49, 1
    s_waitcnt lgkmcnt(0)
    v_readfirstlane_b32 s51, v100
    s_cmp_ge_i32 s51, s50
    s_cbranch_scc1 L_wd_21
    s_cmp_gt_u32 s49, 800000
    s_cbranch_scc1 L_wd_21
    s_sleep 1
    s_branch L_wp_20
L_wd_21:
    ds_read_b128 v[28:31], v123 offset:0
    ds_read_b128 v[32:35], v123 offset:1024
    ds_read_b128 v[36:39], v123 offset:2048
    ds_read_b128 v[40:43], v123 offset:3072
    ds_read_b128 v[44:47], v123 offset:4096
    ds_read_b128 v[48:51], v123 offset:5120
    ds_read_b128 v[52:55], v123 offset:6144
    s_waitcnt lgkmcnt(0)
L_e_wok:
    v_and_b32 v12, v8, v60
    v_and_b32 v13, v9, v60
    v_and_b32 v14, v10, v60
    v_and_b32 v15, v11, v60
    v_and_b32 v16, v8, v61
    v_and_b32 v17, v9, v61
    v_and_b32 v18, v10, v61
    v_and_b32 v19, v11, v61
    v_mfma_f32_16x16x32_bf16 v[20:23], v[12:15], v[28:31], v[20:23]
    v_and_b32 v12, v8, v62
    v_and_b32 v13, v9, v62
    v_and_b32 v14, v10, v62
    v_and_b32 v15, v11, v62
    v_mfma_f32_16x16x32_bf16 v[20:23], v[16:19], v[32:35], v[20:23]
    v_and_b32 v16, v8, v63
    v_and_b32 v17, v9, v63
    v_and_b32 v18, v10, v63
    v_and_b32 v19, v11, v63
    v_mfma_f32_16x16x32_bf16 v[20:23], v[12:15], v[36:39], v[20:23]
    v_and_b32 v12, v8, v64
    v_and_b32 v13, v9, v64
    v_and_b32 v14, v10, v64
    v_and_b32 v15, v11, v64
    v_mfma_f32_16x16x32_bf16 v[20:23], v[16:19], v[40:43], v[20:23]
    v_and_b32 v16, v8, v65
    v_and_b32 v17, v9, v65
    v_and_b32 v18, v10, v65
    v_and_b32 v19, v11, v65
    v_mfma_f32_16x16x32_bf16 v[20:23], v[12:15], v[44:47], v[20:23]
    v_and_b32 v12, v8, v66
    v_and_b32 v13, v9, v66
    v_and_b32 v14, v10, v66
    v_and_b32 v15, v11, v66
    v_mfma_f32_16x16x32_bf16 v[20:23], v[16:19], v[48:51], v[20:23]
    s_nop 1
    v_mfma_f32_16x16x32_bf16 v[20:23], v[12:15], v[52:55], v[20:23]
    s_nop 6
    s_mov_b64 exec, 0xffffffff
    ds_write_b128 v119, v[20:23] offset:21760
    s_mov_b64 exec, -1
    s_mov_b64 exec, 1
    ds_add_u32 v122, v69 offset:16
    s_mov_b64 exec, -1
    s_mov_b32 s49, 0
L_cs_22:
    ds_read_b32 v84, v122 offset:16
    ds_read_b128 v[100:103], v120 offset:21760
    s_add_u32 s49, s49, 1
    s_waitcnt lgkmcnt(0)
    v_readfirstlane_b32 s51, v84
    s_cmp_ge_u32 s51, 8
    s_cbranch_scc1 L_cd_23
    s_cmp_le_u32 s49, 800000
    s_cbranch_scc1 L_cs_22
L_cd_23:
    v_add_f32_dpp v100, v100, v100 row_ror:4 row_mask:0xf bank_mask:0xf
    v_add_f32_dpp v101, v101, v101 row_ror:4 row_mask:0xf bank_mask:0xf
    v_add_f32_dpp v102, v102, v102 row_ror:4 row_mask:0xf bank_mask:0xf
    v_add_f32_dpp v103, v103, v103 row_ror:4 row_mask:0xf bank_mask:0xf
    v_add_f32_dpp v100, v100, v100 row_ror:8 row_mask:0xf bank_mask:0xf
    v_add_f32_dpp v101, v101, v101 row_ror:8 row_mask:0xf bank_mask:0xf
    v_add_f32_dpp v102, v102, v102 row_ror:8 row_mask:0xf bank_mask:0xf
    v_add_f32_dpp v103, v103, v103 row_ror:8 row_mask:0xf bank_mask:0xf
    v_mov_b32 v104, v100
    v_mov_b32 v105, v101
    v_mov_b32 v106, v102
    v_mov_b32 v107, v103
    s_nop 0
    v_permlane16_swap_b32 v100, v104
    v_permlane16_swap_b32 v101, v105
    v_permlane16_swap_b32 v102, v106
    v_permlane16_swap_b32 v103, v107
    v_pk_add_f32 v[100:101], v[100:101], v[104:105]
    v_pk_add_f32 v[102:103], v[102:103], v[106:107]
    v_bfi_b32 v100, s52, v68, v100
    v_bfi_b32 v101, s52, v68, v101
    v_bfi_b32 v102, s52, v68, v102
    v_bfi_b32 v103, s52, v68, v103
    s_mov_b64 exec, 0xf
    global_store_dwordx4 v109, v[100:103], s[28:29] sc1
    s_mov_b64 exec, -1
    s_branch L_end
L_lworker:
    s_and_b32 s38, s31, 3
    s_lshl_b32 s38, s38, 4
    s_add_u32 s59, s38, s32
    s_lshl_b32 s38, s59, 4
    v_and_b32 v7, 3, v1
    v_lshl_add_u32 v127, v7, 2, v3
    v_add_u32 v127, s38, v127
    v_lshlrev_b32 v127, 1, v127
    global_load_ushort v125, v127, s[4:5]
    global_load_ushort v126, v127, s[22:23]
    s_lshl_b32 s45, s30, 12
    v_lshrrev_b32 v7, 2, v1
    s_lshl_b32 s38, s42, 5
    v_lshl_add_u32 v7, v7, 1, s38
    v_lshlrev_b32 v140, 6, v7
    v_add_u32 v140, 196608, v140
    v_lshlrev_b32 v139, 9, v7
    v_and_b32 v7, 3, v1
    v_lshl_add_u32 v139, v7, 4, v139
    s_lshl_b32 s38, s30, 6
    s_add_u32 s38, s38, 524288
    v_add_u32 v139, s38, v139
    v_bfe_u32 v7, v1, 3, 1
    v_lshlrev_b32 v144, 11, v7
    v_lshl_add_u32 v144, v6, 7, v144
    v_add_u32 v144, s45, v144
    v_xor_b32 v7, v3, v6
    v_lshl_add_u32 v128, v7, 4, v144
    v_xor_b32 v7, 4, v7
    v_lshl_add_u32 v129, v7, 4, v144
    v_lshrrev_b32 v7, 5, v1
    v_lshlrev_b32 v130, 11, v7
    v_bfe_u32 v144, v1, 4, 1
    v_lshl_add_u32 v130, v144, 7, v130
    v_lshl_add_u32 v130, v4, 3, v130
    s_lshl_b32 s38, s30, 8
    s_add_u32 s38, s38, 59392
    v_add_u32 v130, s38, v130
    s_lshl_b32 s38, s33, 3
    s_add_u32 s38, s38, s30
    s_lshl_b32 s38, s38, 9
    s_add_u32 s38, s38, 0
    v_lshlrev_b32 v131, 14, v7
    v_and_b32 v144, 31, v1
    v_lshl_add_u32 v131, v144, 4, v131
    v_add_u32 v131, s38, v131
    v_add_u32 v132, 0x8000, v131
    v_add_u32 v142, 0x10000, v131
    v_add_u32 v143, 0x18000, v131
    s_mul_i32 s38, s30, 272
    v_lshlrev_b32 v133, 3, v144
    v_lshl_add_u32 v133, v7, 2, v133
    v_add_u32 v133, s38, v133
    v_mul_u32_u24 v134, 272, v6
    v_lshl_add_u32 v134, v3, 4, v134
    s_lshr_b32 s38, s30, 1
    s_lshl_b32 s38, s38, 10
    s_and_b32 s39, s30, 1
    s_lshl_b32 s39, s39, 3
    s_add_u32 s38, s38, s39
    v_lshl_add_u32 v135, v1, 4, s38
    v_lshlrev_b32 v137, 5, v4
    s_lshl_b32 s38, s30, 2
    v_add_u32 v136, s38, v137
    s_lshl_b32 s38, s33, 8
    s_add_u32 s38, s38, s34
    v_lshl_add_u32 v7, v4, 5, s38
    v_lshlrev_b32 v7, 9, v7
    s_lshl_b32 s39, s30, 6
    s_add_u32 s39, s39, 524288
    v_add_u32 v7, s39, v7
    s_lshl_b32 s39, s30, 5
    s_add_u32 s38, s38, s39
    s_lshl_b32 s38, s38, 6
    s_add_u32 s38, s38, 196608
    v_mov_b32 v144, s38
    v_cmp_gt_u32 vcc, 8, v4
    s_nop 1
    v_cndmask_b32 v7, v144, v7, vcc
    v_lshl_add_u32 v138, v3, 4, v7
    s_lshl_b32 s38, s30, 10
    v_lshlrev_b32 v119, 5, v4
    v_lshl_add_u32 v119, v3, 4, v119
    v_add_u32 v119, s38, v119
    v_lshlrev_b32 v120, 10, v5
    v_lshl_add_u32 v120, v6, 4, v120
    s_lshl_b32 s38, s30, 7
    v_add_u32 v120, s38, v120
    s_lshl_b32 s38, s43, 4
    s_lshl_b32 s39, s30, 1
    s_add_u32 s38, s38, s39
    s_mul_i32 s38, s38, 3072
    s_lshl_b32 s39, s42, 6
    s_add_u32 s38, s38, s39
    s_add_u32 s38, s38, 263168
    v_bfe_u32 v141, v1, 2, 1
    v_mul_u32_u24 v141, 3072, v141
    v_and_b32 v7, 3, v1
    v_lshl_add_u32 v141, v7, 4, v141
    v_add_u32 v141, s38, v141
    s_lshl_b32 s38, s30, 13
    s_add_u32 s38, s38, 92160
    v_lshl_add_u32 v123, v1, 4, s38
    v_mov_b32 v92, 0
    v_mov_b32 v93, 0
    v_mov_b32 v94, 0
    v_mov_b32 v95, 0
    v_mov_b32 v88, 0
    v_mov_b32 v89, 0
    v_mov_b32 v90, 0
    v_mov_b32 v91, 0
    s_mov_b32 s39, 0
    s_movk_i32 s38, 63
    s_mov_b32 s40, 0x3db504f3
    s_mov_b32 s41, 0x3fb8aa3b
    s_waitcnt vmcnt(0)
    v_add_u32 v68, 1, v68
    v_and_b32 v68, 0xfff, v68
    s_movk_i32 s50, 80
    s_cmp_ge_u32 s31, 4
    s_cmovk_i32 s50, 80
    s_mov_b32 s49, 0
L_wp_24:
    ds_read_b32 v144, v122
    s_add_u32 s49, s49, 1
    s_waitcnt lgkmcnt(0)
    v_readfirstlane_b32 s51, v144
    s_cmp_ge_i32 s51, s50
    s_cbranch_scc1 L_wd_25
    s_cmp_gt_u32 s49, 800000
    s_cbranch_scc1 L_wd_25
    s_sleep 1
    s_branch L_wp_24
L_wd_25:
    global_load_dwordx4 v[72:75], v131, s[28:29] sc1
    global_load_dwordx4 v[76:79], v132, s[28:29] sc1
    global_load_dwordx4 v[80:83], v142, s[28:29] sc1
    global_load_dwordx4 v[84:87], v143, s[28:29] sc1
    s_mov_b64 exec, 1
    ds_add_u32 v122, v69 offset:20
    s_mov_b64 exec, -1
    ds_read_b128 v[28:31], v128 offset:26624
    ds_read_b128 v[32:35], v129 offset:26624
    ds_read_b128 v[36:39], v128 offset:27648
    ds_read_b128 v[40:43], v129 offset:27648
    ds_read_b64_tr_b16 v[44:45], v130 offset:0
    ds_read_b64_tr_b16 v[46:47], v130 offset:4096
    ds_read_b64_tr_b16 v[48:49], v130 offset:8192
    ds_read_b64_tr_b16 v[50:51], v130 offset:12288
    ds_read_b64_tr_b16 v[52:53], v130 offset:16384
    ds_read_b64_tr_b16 v[54:55], v130 offset:20480
    ds_read_b64_tr_b16 v[56:57], v130 offset:24576
    ds_read_b64_tr_b16 v[58:59], v130 offset:28672
    v_mov_b32 v96, 0
    v_mov_b32 v100, s36
    v_mov_b32 v97, 0
    v_mov_b32 v101, s36
    v_mov_b32 v98, 0
    v_mov_b32 v102, s36
    v_mov_b32 v99, 0
    v_mov_b32 v103, s36
    v_lshlrev_b32 v7, 4, v1
    s_waitcnt vmcnt(0)
    s_branch L_l_qchk
L_l_q:
    s_sleep 1
    global_load_dwordx4 v[72:75], v131, s[28:29] sc1
    global_load_dwordx4 v[76:79], v132, s[28:29] sc1
    global_load_dwordx4 v[80:83], v142, s[28:29] sc1
    global_load_dwordx4 v[84:87], v143, s[28:29] sc1
    s_waitcnt vmcnt(0)
L_l_qchk:
    s_add_u32 s39, s39, 1
    v_bitop3_b32 v144, v72, v73, v68 bitop3:0x7e
    v_bitop3_b32 v145, v74, v75, v68 bitop3:0x7e
    v_bitop3_b32 v146, v76, v77, v68 bitop3:0x7e
    v_bitop3_b32 v147, v78, v79, v68 bitop3:0x7e
    v_bitop3_b32 v148, v80, v81, v68 bitop3:0x7e
    v_bitop3_b32 v149, v82, v83, v68 bitop3:0x7e
    v_bitop3_b32 v150, v84, v85, v68 bitop3:0x7e
    v_bitop3_b32 v151, v86, v87, v68 bitop3:0x7e
    v_or3_b32 v144, v144, v145, v146
    v_or3_b32 v147, v147, v148, v149
    v_or_b32 v150, v150, v151
    v_or3_b32 v144, v144, v147, v150
    v_and_b32 v144, s38, v144
    v_cmp_ne_u32 vcc, 0, v144
    s_cmp_gt_u32 s39, 200000
    s_cbranch_scc1 L_l_qd
    s_cbranch_vccnz L_l_q
L_l_qd:
    v_and_b32 v72, 4294967232, v72
    v_and_b32 v73, 4294967232, v73
    v_and_b32 v74, 4294967232, v74
    v_and_b32 v75, 4294967232, v75
    v_and_b32 v76, 4294967232, v76
    v_and_b32 v77, 4294967232, v77
    v_and_b32 v78, 4294967232, v78
    v_and_b32 v79, 4294967232, v79
    v_and_b32 v80, 4294967232, v80
    v_and_b32 v81, 4294967232, v81
    v_and_b32 v82, 4294967232, v82
    v_and_b32 v83, 4294967232, v83
    v_and_b32 v84, 4294967232, v84
    v_and_b32 v85, 4294967232, v85
    v_and_b32 v86, 4294967232, v86
    v_and_b32 v87, 4294967232, v87
    v_pk_add_f32 v[72:73], v[72:73], v[76:77]
    v_pk_add_f32 v[74:75], v[74:75], v[78:79]
    v_pk_add_f32 v[80:81], v[80:81], v[84:85]
    v_pk_add_f32 v[82:83], v[82:83], v[86:87]
    v_pk_add_f32 v[72:73], v[72:73], v[80:81]
    v_pk_add_f32 v[74:75], v[74:75], v[82:83]
    s_nop 1
    v_permlane32_swap_b32 v72, v74
    v_permlane32_swap_b32 v73, v75
    v_pk_add_f32 v[72:73], v[72:73], v[74:75]
    v_cvt_pk_bf16_f32 v72, v72, v73
    ds_write_b32 v133, v72 offset:0
    s_mov_b64 exec, 1
    ds_add_u32 v122, v69 offset:4
    s_mov_b64 exec, -1
    s_mov_b32 s49, 0
L_cs_26:
    ds_read_b32 v144, v122 offset:4
    ds_read_b128 v[72:75], v134 offset:0
    ds_read_b128 v[76:79], v134 offset:64
    ds_read_b128 v[80:83], v134 offset:128
    ds_read_b128 v[84:87], v134 offset:192
    s_add_u32 s49, s49, 1
    s_waitcnt lgkmcnt(0)
    v_readfirstlane_b32 s51, v144
    s_cmp_ge_u32 s51, 8
    s_cbranch_scc1 L_cd_27
    s_cmp_le_u32 s49, 800000
    s_cbranch_scc1 L_cs_26
L_cd_27:
    v_mfma_f32_16x16x32_bf16 v[92:95], v[28:31], v[72:75], v[92:95]
    v_mfma_f32_16x16x32_bf16 v[92:95], v[32:35], v[76:79], v[92:95]
    v_mfma_f32_16x16x32_bf16 v[92:95], v[36:39], v[80:83], v[92:95]
    v_mfma_f32_16x16x32_bf16 v[92:95], v[40:43], v[84:87], v[92:95]
    s_mov_b32 s44, s40
    s_mov_b32 s45, s40
    s_nop 5
    v_cvt_pk_bf16_f32 v144, v92, v93
    v_cvt_pk_bf16_f32 v145, v94, v95
    v_lshlrev_b32 v92, 16, v144
    v_and_b32 v93, 0xffff0000, v144
    v_lshlrev_b32 v94, 16, v145
    v_and_b32 v95, 0xffff0000, v145
    v_pk_mul_f32 v[92:93], v[92:93], s[44:45]
    v_pk_mul_f32 v[94:95], v[94:95], s[44:45]
    v_cvt_pk_bf16_f32 v144, v92, v93
    v_cvt_pk_bf16_f32 v145, v94, v95
    v_lshlrev_b32 v92, 16, v144
    v_and_b32 v93, 0xffff0000, v144
    v_lshlrev_b32 v94, 16, v145
    v_and_b32 v95, 0xffff0000, v145
    v_max3_f32 v144, v92, v93, v94
    v_max_f32 v144, v144, v95
    v_mov_b32 v145, v144
    s_nop 1
    v_permlane32_swap_b32 v144, v145
    v_max_f32 v144, v144, v145
    v_mov_b32 v145, v144
    s_nop 1
    v_permlane16_swap_b32 v144, v145
    v_max_f32 v144, v144, v145
    ds_write_b32 v136, v144 offset:2176
    s_mov_b64 exec, 1
    ds_add_u32 v122, v69 offset:8
    s_mov_b64 exec, -1
    s_mov_b32 s49, 0
L_cs_28:
    ds_read_b32 v144, v122 offset:8
    ds_read_b128 v[72:75], v137 offset:2176
    ds_read_b128 v[76:79], v137 offset:2192
    s_add_u32 s49, s49, 1
    s_waitcnt lgkmcnt(0)
    v_readfirstlane_b32 s51, v144
    s_cmp_ge_u32 s51, 8
    s_cbranch_scc1 L_cd_29
    s_cmp_le_u32 s49, 800000
    s_cbranch_scc1 L_cs_28
L_cd_29:
    v_max3_f32 v144, v72, v73, v74
    v_max3_f32 v145, v75, v76, v77
    v_max3_f32 v144, v144, v78, v79
    v_max_f32 v148, v144, v145
    v_mul_f32 v144, s41, v148
    v_fma_f32 v92, v92, s41, -v144
    v_fma_f32 v93, v93, s41, -v144
    v_fma_f32 v94, v94, s41, -v144
    v_fma_f32 v95, v95, s41, -v144
    v_exp_f32 v92, v92
    v_exp_f32 v93, v93
    v_exp_f32 v94, v94
    v_exp_f32 v95, v95
    v_readlane_b32 s44, v148, s30
    v_cvt_pk_bf16_f32 v144, v92, v93
    v_cvt_pk_bf16_f32 v145, v94, v95
    ds_write_b64 v135, v[144:145] offset:13568
    s_mov_b64 exec, 1
    ds_add_u32 v122, v69 offset:12
    s_mov_b64 exec, -1
    v_mov_b32 v149, s44
    v_cmp_gt_u32 vcc, 8, v4
    s_mov_b32 s38, 0x01ff01ff
    s_mov_b32 s39, 0x01ff01ff
    s_mov_b32 s49, 0
L_cs_30:
    ds_read_b32 v144, v122 offset:12
    ds_read_b128 v[72:75], v7 offset:13568
    ds_read_b128 v[76:79], v7 offset:14592
    ds_read_b128 v[80:83], v7 offset:15616
    ds_read_b128 v[84:87], v7 offset:16640
    s_add_u32 s49, s49, 1
    s_waitcnt lgkmcnt(0)
    v_readfirstlane_b32 s51, v144
    s_cmp_ge_u32 s51, 8
    s_cbranch_scc1 L_cd_31
    s_cmp_le_u32 s49, 800000
    s_cbranch_scc1 L_cs_30
L_cd_31:
    v_mfma_f32_16x16x32_bf16 v[96:99], v[100:103], v[72:75], v[96:99]
    v_mfma_f32_16x16x32_bf16 v[96:99], v[100:103], v[76:79], v[96:99]
    v_mfma_f32_16x16x32_bf16 v[96:99], v[100:103], v[80:83], v[96:99]
    v_mfma_f32_16x16x32_bf16 v[96:99], v[100:103], v[84:87], v[96:99]
    v_mfma_f32_16x16x32_bf16 v[88:91], v[44:47], v[72:75], v[88:91]
    v_mfma_f32_16x16x32_bf16 v[88:91], v[48:51], v[76:79], v[88:91]
    v_mfma_f32_16x16x32_bf16 v[88:91], v[52:55], v[80:83], v[88:91]
    v_mfma_f32_16x16x32_bf16 v[88:91], v[56:59], v[84:87], v[88:91]
    s_nop 3
    v_readlane_b32 s45, v96, s30
    s_nop 1
    v_mov_b32 v150, s45
    s_nop 0
    v_cndmask_b32 v88, v149, v88, vcc
    v_cndmask_b32 v89, v150, v89, vcc
    v_cndmask_b32 v90, 0, v90, vcc
    v_cndmask_b32 v91, 0, v91, vcc
    v_bfi_b32 v88, s52, v68, v88
    v_bfi_b32 v89, s52, v68, v89
    v_bfi_b32 v90, s52, v68, v90
    v_bfi_b32 v91, s52, v68, v91
    s_mov_b64 exec, s[38:39]
    global_store_dwordx4 v138, v[88:91], s[28:29] sc1
    s_mov_b64 exec, -1
    s_mov_b32 s39, 0
    s_waitcnt vmcnt(0)
    s_sleep 10
L_l_o:
    global_load_dwordx4 v[80:83], v140, s[28:29] sc1
    global_load_dwordx4 v[84:87], v140, s[28:29] offset:64 sc1
    global_load_dwordx4 v[72:75], v139, s[28:29] sc1
    global_load_dwordx4 v[76:79], v139, s[28:29] offset:512 sc1
    s_add_u32 s39, s39, 1
    s_waitcnt vmcnt(0)
    v_bitop3_b32 v144, v72, v73, v68 bitop3:0x7e
    v_bitop3_b32 v145, v74, v75, v68 bitop3:0x7e
    v_bitop3_b32 v146, v76, v77, v68 bitop3:0x7e
    v_bitop3_b32 v147, v78, v79, v68 bitop3:0x7e
    v_bitop3_b32 v148, v80, v81, v68 bitop3:0x7e
    v_bitop3_b32 v149, v82, v83, v68 bitop3:0x7e
    v_bitop3_b32 v150, v84, v85, v68 bitop3:0x7e
    v_bitop3_b32 v151, v86, v87, v68 bitop3:0x7e
    v_or3_b32 v144, v144, v145, v146
    v_or3_b32 v147, v147, v148, v149
    v_or_b32 v150, v150, v151
    v_or3_b32 v144, v144, v147, v150
    v_and_b32 v144, s52, v144
    v_cmp_ne_u32 vcc, 0, v144
    s_cmp_gt_u32 s39, 200000
    s_cbranch_scc1 L_l_od
    s_cbranch_vccz L_l_od
    s_sleep 6
    s_branch L_l_o
L_l_od:
    s_lshl_b32 s50, s64, 3
    s_add_u32 s50, s50, 64
    ds_read_b32 v92, v122
    ds_read_b128 v[28:31], v123 offset:0
    ds_read_b128 v[32:35], v123 offset:1024
    ds_read_b128 v[36:39], v123 offset:2048
    ds_read_b128 v[40:43], v123 offset:3072
    ds_read_b128 v[44:47], v123 offset:4096
    ds_read_b128 v[48:51], v123 offset:5120
    ds_read_b128 v[52:55], v123 offset:6144
    ds_read_b128 v[56:59], v123 offset:7168
    v_and_b32 v80, 0xffff0000, v80
    v_and_b32 v84, 0xffff0000, v84
    v_max_f32 v144, v80, v84
    v_and_b32 v72, 0xffffff00, v72
    v_and_b32 v73, 0xffffff00, v73
    v_max_f32_dpp v144, v144, v144 row_ror:4 row_mask:0xf bank_mask:0xf
    v_and_b32 v74, 0xffffff00, v74
    v_and_b32 v75, 0xffffff00, v75
    v_max_f32_dpp v144, v144, v144 row_ror:8 row_mask:0xf bank_mask:0xf
    v_mov_b32 v146, v144
    v_and_b32 v76, 0xffffff00, v76
    v_and_b32 v77, 0xffffff00, v77
    v_permlane16_swap_b32 v144, v146
    v_max_f32 v144, v144, v146
    v_mov_b32 v146, v144
    v_and_b32 v78, 0xffffff00, v78
    v_and_b32 v79, 0xffffff00, v79
    v_permlane32_swap_b32 v144, v146
    v_and_b32 v81, 0xffffff00, v81
    v_and_b32 v85, 0xffffff00, v85
    v_max_f32 v144, v144, v146
    v_mul_f32 v144, s41, v144
    v_fma_f32 v80, v80, s41, -v144
    v_fma_f32 v84, v84, s41, -v144
    v_exp_f32 v80, v80
    v_exp_f32 v84, v84
    s_nop 0
    v_mul_f32 v145, v80, v81
    v_mul_f32 v148, v80, v72
    v_mul_f32 v149, v80, v73
    v_mul_f32 v150, v80, v74
    v_mul_f32 v151, v80, v75
    v_fmac_f32 v145, v84, v85
    v_fmac_f32 v148, v84, v76
    v_fmac_f32 v149, v84, v77
    v_fmac_f32 v150, v84, v78
    v_fmac_f32 v151, v84, v79
    v_mov_b32 v146, v145
    s_nop 1
    v_permlane32_swap_b32 v148, v150
    v_permlane32_swap_b32 v149, v151
    v_permlane32_swap_b32 v145, v146
    v_add_f32 v148, v148, v150
    v_add_f32 v149, v149, v151
    v_add_f32 v145, v145, v146
    v_mov_b32 v146, v145
    s_nop 1
    v_permlane16_swap_b32 v148, v149
    v_permlane16_swap_b32 v145, v146
    v_add_f32 v148, v148, v149
    v_add_f32 v145, v145, v146
    s_nop 0
    v_add_f32_dpp v148, v148, v148 row_ror:4 row_mask:0xf bank_mask:0xf
    v_add_f32_dpp v145, v145, v145 row_ror:4 row_mask:0xf bank_mask:0xf
    s_nop 0
    v_add_f32_dpp v148, v148, v148 row_ror:8 row_mask:0xf bank_mask:0xf
    v_add_f32_dpp v145, v145, v145 row_ror:8 row_mask:0xf bank_mask:0xf
    s_nop 0
    v_rcp_f32 v145, v145
    s_nop 0
    v_mul_f32 v148, v148, v145
    v_cvt_pk_bf16_f32 v148, v148, v148
    s_nop 1
    v_mov_b32_dpp v60, v148 quad_perm:[0,0,0,0] row_mask:0xf bank_mask:0xf
    v_mov_b32_dpp v61, v148 quad_perm:[1,1,1,1] row_mask:0xf bank_mask:0xf
    v_mov_b32_dpp v62, v148 quad_perm:[2,2,2,2] row_mask:0xf bank_mask:0xf
    v_mov_b32_dpp v63, v148 quad_perm:[3,3,3,3] row_mask:0xf bank_mask:0xf
    s_waitcnt lgkmcnt(0)
    v_readfirstlane_b32 s51, v92
    s_cmp_ge_i32 s51, s50
    s_cbranch_scc1 L_l_wok
    s_mov_b32 s49, 0
L_wp_32:
    ds_read_b32 v144, v122
    s_add_u32 s49, s49, 1
    s_waitcnt lgkmcnt(0)
    v_readfirstlane_b32 s51, v144
    s_cmp_ge_i32 s51, s50
    s_cbranch_scc1 L_wd_33
    s_cmp_gt_u32 s49, 800000
    s_cbranch_scc1 L_wd_33
    s_sleep 1
    s_branch L_wp_32
L_wd_33:
    ds_read_b128 v[28:31], v123 offset:0
    ds_read_b128 v[32:35], v123 offset:1024
    ds_read_b128 v[36:39], v123 offset:2048
    ds_read_b128 v[40:43], v123 offset:3072
    ds_read_b128 v[44:47], v123 offset:4096
    ds_read_b128 v[48:51], v123 offset:5120
    ds_read_b128 v[52:55], v123 offset:6144
    ds_read_b128 v[56:59], v123 offset:7168
    s_waitcnt lgkmcnt(0)
L_l_wok:
    v_and_b32 v12, v8, v60
    v_and_b32 v13, v9, v60
    v_and_b32 v14, v10, v60
    v_and_b32 v15, v11, v60
    v_and_b32 v16, v8, v61
    v_and_b32 v17, v9, v61
    v_and_b32 v18, v10, v61
    v_and_b32 v19, v11, v61
    v_mfma_f32_16x16x32_bf16 v[20:23], v[12:15], v[28:31], v[20:23]
    v_mfma_f32_16x16x32_bf16 v[24:27], v[12:15], v[32:35], v[24:27]
    v_and_b32 v12, v8, v62
    v_and_b32 v13, v9, v62
    v_and_b32 v14, v10, v62
    v_and_b32 v15, v11, v62
    v_mfma_f32_16x16x32_bf16 v[20:23], v[16:19], v[36:39], v[20:23]
    v_mfma_f32_16x16x32_bf16 v[24:27], v[16:19], v[40:43], v[24:27]
    v_and_b32 v16, v8, v63
    v_and_b32 v17, v9, v63
    v_and_b32 v18, v10, v63
    v_and_b32 v19, v11, v63
    v_mfma_f32_16x16x32_bf16 v[20:23], v[12:15], v[44:47], v[20:23]
    v_mfma_f32_16x16x32_bf16 v[24:27], v[12:15], v[48:51], v[24:27]
    s_nop 1
    v_mfma_f32_16x16x32_bf16 v[20:23], v[16:19], v[52:55], v[20:23]
    v_mfma_f32_16x16x32_bf16 v[24:27], v[16:19], v[56:59], v[24:27]
    s_nop 6
    s_mov_b64 exec, 0xffffffff
    ds_write_b128 v119, v[20:23] offset:17664
    ds_write_b128 v119, v[24:27] offset:18176
    s_mov_b64 exec, -1
    s_mov_b64 exec, 1
    ds_add_u32 v122, v69 offset:16
    s_mov_b64 exec, -1
    s_mov_b32 s49, 0
L_cs_34:
    ds_read_b32 v144, v122 offset:16
    ds_read_b128 v[72:75], v120 offset:17664
    s_add_u32 s49, s49, 1
    s_waitcnt lgkmcnt(0)
    v_readfirstlane_b32 s51, v144
    s_cmp_ge_u32 s51, 8
    s_cbranch_scc1 L_cd_35
    s_cmp_le_u32 s49, 800000
    s_cbranch_scc1 L_cs_34
L_cd_35:
    v_add_f32_dpp v72, v72, v72 row_ror:8 row_mask:0xf bank_mask:0xf
    v_add_f32_dpp v73, v73, v73 row_ror:8 row_mask:0xf bank_mask:0xf
    v_add_f32_dpp v74, v74, v74 row_ror:8 row_mask:0xf bank_mask:0xf
    v_add_f32_dpp v75, v75, v75 row_ror:8 row_mask:0xf bank_mask:0xf
    v_mov_b32 v76, v72
    v_mov_b32 v77, v73
    v_mov_b32 v78, v74
    v_mov_b32 v79, v75
    s_nop 0
    v_permlane16_swap_b32 v72, v76
    v_permlane16_swap_b32 v73, v77
    v_permlane16_swap_b32 v74, v78
    v_permlane16_swap_b32 v75, v79
    v_pk_add_f32 v[72:73], v[72:73], v[76:77]
    v_pk_add_f32 v[74:75], v[74:75], v[78:79]
    v_mov_b32 v76, v72
    v_mov_b32 v77, v73
    v_mov_b32 v78, v74
    v_mov_b32 v79, v75
    s_nop 0
    v_permlane32_swap_b32 v72, v76
    v_permlane32_swap_b32 v73, v77
    v_permlane32_swap_b32 v74, v78
    v_permlane32_swap_b32 v75, v79
    v_pk_add_f32 v[72:73], v[72:73], v[76:77]
    v_pk_add_f32 v[74:75], v[74:75], v[78:79]
    v_bfi_b32 v72, s52, v68, v72
    v_bfi_b32 v73, s52, v68, v73
    v_bfi_b32 v74, s52, v68, v74
    v_bfi_b32 v75, s52, v68, v75
    s_mov_b64 exec, 0xff
    global_store_dwordx4 v141, v[72:75], s[28:29] sc1
    s_mov_b64 exec, -1
    s_cmp_lt_u32 s31, 4
    s_cbranch_scc1 L_end
    s_cmp_lg_u32 s30, 0
    s_cbranch_scc1 L_end
    v_and_b32 v144, 3, v1
    s_mul_i32 s38, s59, 3072
    s_add_u32 s38, s38, 262144
    v_lshl_add_u32 v7, v1, 4, s38
    s_mov_b32 s39, 0
    v_lshlrev_b32 v125, 16, v125
    v_lshlrev_b32 v126, 16, v126
    s_waitcnt vmcnt(0)
L_f:
    global_load_dwordx4 v[28:31], v7, s[28:29] offset:0 sc1
    global_load_dwordx4 v[32:35], v7, s[28:29] offset:1024 sc1
    global_load_dwordx4 v[36:39], v7, s[28:29] offset:2048 sc1
    s_add_u32 s39, s39, 1
    s_waitcnt vmcnt(0)
    v_bitop3_b32 v100, v28, v29, v68 bitop3:0x7e
    v_bitop3_b32 v101, v30, v31, v68 bitop3:0x7e
    v_bitop3_b32 v102, v32, v33, v68 bitop3:0x7e
    v_bitop3_b32 v103, v34, v35, v68 bitop3:0x7e
    v_bitop3_b32 v104, v36, v37, v68 bitop3:0x7e
    v_bitop3_b32 v105, v38, v39, v68 bitop3:0x7e
    v_or3_b32 v100, v100, v101, v102
    v_or3_b32 v103, v103, v104, v105
    v_or_b32 v100, v100, v103
    v_and_b32 v100, s52, v100
    v_cmp_ne_u32 vcc, 0, v100
    s_cmp_gt_u32 s39, 200000
    s_cbranch_scc1 L_fd
    s_cbranch_vccz L_fd
    s_sleep 2
    s_branch L_f
L_fd:
    v_and_b32 v28, 0xffffff00, v28
    v_and_b32 v29, 0xffffff00, v29
    v_and_b32 v30, 0xffffff00, v30
    v_and_b32 v31, 0xffffff00, v31
    v_and_b32 v32, 0xffffff00, v32
    v_and_b32 v33, 0xffffff00, v33
    v_and_b32 v34, 0xffffff00, v34
    v_and_b32 v35, 0xffffff00, v35
    v_and_b32 v36, 0xffffff00, v36
    v_and_b32 v37, 0xffffff00, v37
    v_and_b32 v38, 0xffffff00, v38
    v_and_b32 v39, 0xffffff00, v39
    v_add_f32 v32, v32, v36
    v_add_f32 v33, v33, v37
    v_add_f32 v34, v34, v38
    v_add_f32 v35, v35, v39
    v_permlane32_swap_b32 v28, v30
    v_permlane32_swap_b32 v29, v31
    v_permlane32_swap_b32 v32, v34
    v_permlane32_swap_b32 v33, v35
    v_add_f32 v28, v28, v30
    v_add_f32 v29, v29, v31
    v_add_f32 v32, v32, v34
    v_add_f32 v33, v33, v35
    s_nop 0
    v_permlane16_swap_b32 v28, v29
    v_permlane16_swap_b32 v32, v33
    v_add_f32 v28, v28, v29
    v_add_f32 v32, v32, v33
    s_nop 0
    v_add_f32_dpp v28, v28, v28 row_ror:8 row_mask:0xf bank_mask:0xf
    v_add_f32_dpp v32, v32, v32 row_ror:8 row_mask:0xf bank_mask:0xf
    s_nop 0
    v_add_f32_dpp v28, v28, v28 row_ror:4 row_mask:0xf bank_mask:0xf
    v_add_f32_dpp v32, v32, v32 row_ror:4 row_mask:0xf bank_mask:0xf
    v_cvt_pk_bf16_f32 v100, v32, v28
    v_lshlrev_b32 v32, 16, v100
    v_and_b32 v28, 0xffff0000, v100
    v_add_f32 v32, v32, v125
    v_add_f32 v28, v28, v126
    v_cvt_pk_bf16_f32 v100, v32, v28
    v_lshlrev_b32 v32, 16, v100
    v_and_b32 v28, 0xffff0000, v100
    v_add_f32 v32, v32, v28
    v_cvt_pk_bf16_f32 v32, v32, v32
    s_mov_b32 s38, 0x000f000f
    s_mov_b32 s39, 0x000f000f
    s_mov_b64 exec, s[38:39]
    global_store_short v127, v32, s[24:25]
    s_mov_b64 exec, -1
    s_cmp_lg_u32 s59, 0
    s_cbranch_scc1 L_end
    v_mov_b32 v7, 1048576
    s_mov_b64 exec, 1
    global_store_dword v7, v68, s[28:29] sc1
    s_mov_b64 exec, -1
L_end:
    s_endpgm
L_loader:
    s_setprio 3
    s_mov_b32 s58, 0
    s_bitcmp1_b32 s2, 3
    s_cbranch_scc1 L_ld_l
    s_lshl_b32 s38, s54, 8
    v_lshl_add_u32 v7, v3, 3, s38
    s_movk_i32 s40, 7168
    v_mul_lo_u32 v20, v7, s40
    s_lshl_b32 s38, s55, 8
    v_lshl_add_u32 v20, v4, 4, v20
    v_add_u32 v20, s38, v20
    s_mul_i32 s38, s56, 224
    v_add_u32 v7, s38, v3
    v_lshlrev_b32 v21, 11, v7
    s_lshl_b32 s38, s57, 8
    v_lshl_add_u32 v21, v4, 4, v21
    v_add_u32 v21, s38, v21
    s_mov_b32 s53, 0
    s_mov_b32 s65, 0
    s_mov_b32 s49, 0
L_ld_ew:
    ds_read_b32 v24, v122 offset:4
    s_add_u32 s49, s49, 1
    s_waitcnt lgkmcnt(0)
    v_readfirstlane_b32 s50, v24
    s_cmp_ge_u32 s50, 1
    s_cbranch_scc1 L_ld_ed
    s_cmp_gt_u32 s49, 800000
    s_cbranch_scc1 L_ld_ed
    s_sleep 2
    s_branch L_ld_ew
L_ld_ed:
    s_cmp_ge_u32 s31, 4
    s_cbranch_scc1 L_ld_elate
    s_cmp_ge_u32 s32, s66
    s_cbranch_scc1 L_ld_e2a
    s_movk_i32 s49, 8
L_ld_e1ba:
    s_add_u32 s38, s64, s65
    s_and_b32 s38, s38, 7
    s_mul_i32 s39, s38, 229376
    s_mul_i32 s51, s38, 8192
    s_add_u32 s51, s51, 26624
    v_add_u32 v23, s39, v20
    s_waitcnt vmcnt(24)
    s_sub_u32 s50, s53, 24
    s_max_i32 s58, s58, s50
    v_mov_b32 v22, s58
    ds_write_b32 v122, v22
    s_add_u32 m0, s51, 0
    s_nop 0
    global_load_lds_dwordx4 v23, s[16:17] offset:0 nt
    v_add_u32 v23, 7168, v23
    s_add_u32 m0, s51, 1024
    s_nop 0
    global_load_lds_dwordx4 v23, s[16:17] offset:0 nt
    v_add_u32 v23, 7168, v23
    s_add_u32 m0, s51, 2048
    s_nop 0
    global_load_lds_dwordx4 v23, s[16:17] offset:0 nt
    v_add_u32 v23, 7168, v23
    s_add_u32 m0, s51, 3072
    s_nop 0
    global_load_lds_dwordx4 v23, s[16:17] offset:0 nt
    v_add_u32 v23, 7168, v23
    s_add_u32 s53, s53, 4
    s_waitcnt vmcnt(24)
    s_sub_u32 s50, s53, 24
    s_max_i32 s58, s58, s50
    v_mov_b32 v22, s58
    ds_write_b32 v122, v22
    s_add_u32 m0, s51, 4096
    s_nop 0
    global_load_lds_dwordx4 v23, s[16:17] offset:0 nt
    v_add_u32 v23, 7168, v23
    s_add_u32 m0, s51, 5120
    s_nop 0
    global_load_lds_dwordx4 v23, s[16:17] offset:0 nt
    v_add_u32 v23, 7168, v23
    s_add_u32 m0, s51, 6144
    s_nop 0
    global_load_lds_dwordx4 v23, s[16:17] offset:0 nt
    v_add_u32 v23, 7168, v23
    s_add_u32 m0, s51, 7168
    s_nop 0
    global_load_lds_dwordx4 v23, s[16:17] offset:0 nt
    s_add_u32 s53, s53, 4
    s_add_u32 s65, s65, 1
    s_sub_u32 s49, s49, 1
    s_cmp_lg_u32 s49, 0
    s_cbranch_scc1 L_ld_e1ba
    s_branch L_ld_e3a
L_ld_e2a:
    s_sleep 55
L_ld_e3a:
    s_mov_b32 s65, 0
    s_waitcnt vmcnt(24)
    s_sub_u32 s50, s53, 24
    s_max_i32 s58, s58, s50
    v_mov_b32 v22, s58
    ds_write_b32 v122, v22
    s_movk_i32 s49, 8
L_ld_e2la:
    s_add_u32 s38, s64, s65
    s_and_b32 s38, s38, 7
    s_mul_i32 s39, s38, 57344
    s_mul_i32 s51, s38, 7168
    s_add_u32 s51, s51, 92160
    v_add_u32 v23, s39, v21
    s_waitcnt vmcnt(20)
    s_sub_u32 s50, s53, 20
    s_max_i32 s58, s58, s50
    v_mov_b32 v22, s58
    ds_write_b32 v122, v22
    s_add_u32 m0, s51, 0
    s_nop 0
    global_load_lds_dwordx4 v23, s[20:21] offset:0 nt
    v_add_u32 v23, 8192, v23
    s_add_u32 m0, s51, 1024
    s_nop 0
    global_load_lds_dwordx4 v23, s[20:21] offset:0 nt
    v_add_u32 v23, 8192, v23
    s_add_u32 m0, s51, 2048
    s_nop 0
    global_load_lds_dwordx4 v23, s[20:21] offset:0 nt
    v_add_u32 v23, 8192, v23
    s_add_u32 m0, s51, 3072
    s_nop 0
    global_load_lds_dwordx4 v23, s[20:21] offset:0 nt
    v_add_u32 v23, 8192, v23
    s_add_u32 s53, s53, 4
    s_waitcnt vmcnt(21)
    s_sub_u32 s50, s53, 21
    s_max_i32 s58, s58, s50
    v_mov_b32 v22, s58
    ds_write_b32 v122, v22
    s_add_u32 m0, s51, 4096
    s_nop 0
    global_load_lds_dwordx4 v23, s[20:21] offset:0 nt
    v_add_u32 v23, 8192, v23
    s_add_u32 m0, s51, 5120
    s_nop 0
    global_load_lds_dwordx4 v23, s[20:21] offset:0 nt
    v_add_u32 v23, 8192, v23
    s_add_u32 m0, s51, 6144
    s_nop 0
    global_load_lds_dwordx4 v23, s[20:21] offset:0 nt
    s_add_u32 s53, s53, 3
    s_add_u32 s65, s65, 1
    s_sub_u32 s49, s49, 1
    s_cmp_lg_u32 s49, 0
    s_cbranch_scc1 L_ld_e2la
    s_waitcnt vmcnt(20)
    s_sub_u32 s50, s53, 20
    s_max_i32 s58, s58, s50
    v_mov_b32 v22, s58
    ds_write_b32 v122, v22
    s_waitcnt vmcnt(16)
    s_sub_u32 s50, s53, 16
    s_max_i32 s58, s58, s50
    v_mov_b32 v22, s58
    ds_write_b32 v122, v22
    s_waitcnt vmcnt(12)
    s_sub_u32 s50, s53, 12
    s_max_i32 s58, s58, s50
    v_mov_b32 v22, s58
    ds_write_b32 v122, v22
    s_waitcnt vmcnt(8)
    s_sub_u32 s50, s53, 8
    s_max_i32 s58, s58, s50
    v_mov_b32 v22, s58
    ds_write_b32 v122, v22
    s_waitcnt vmcnt(6)
    s_sub_u32 s50, s53, 6
    s_max_i32 s58, s58, s50
    v_mov_b32 v22, s58
    ds_write_b32 v122, v22
    s_waitcnt vmcnt(4)
    s_sub_u32 s50, s53, 4
    s_max_i32 s58, s58, s50
    v_mov_b32 v22, s58
    ds_write_b32 v122, v22
    s_waitcnt vmcnt(2)
    s_sub_u32 s50, s53, 2
    s_max_i32 s58, s58, s50
    v_mov_b32 v22, s58
    ds_write_b32 v122, v22
    s_waitcnt vmcnt(0)
    s_sub_u32 s50, s53, 0
    s_max_i32 s58, s58, s50
    v_mov_b32 v22, s58
    ds_write_b32 v122, v22
    s_waitcnt lgkmcnt(0)
    s_branch L_ld_end
L_ld_elate:
    s_cmp_ge_u32 s32, s66
    s_cbranch_scc1 L_ld_e2b
    s_movk_i32 s49, 8
L_ld_e1bb:
    s_add_u32 s38, s64, s65
    s_and_b32 s38, s38, 7
    s_mul_i32 s39, s38, 229376
    s_mul_i32 s51, s38, 8192
    s_add_u32 s51, s51, 26624
    v_add_u32 v23, s39, v20
    s_waitcnt vmcnt(24)
    s_sub_u32 s50, s53, 24
    s_max_i32 s58, s58, s50
    v_mov_b32 v22, s58
    ds_write_b32 v122, v22
    s_add_u32 m0, s51, 0
    s_nop 0
    global_load_lds_dwordx4 v23, s[16:17] offset:0 nt
    v_add_u32 v23, 7168, v23
    s_add_u32 m0, s51, 1024
    s_nop 0
    global_load_lds_dwordx4 v23, s[16:17] offset:0 nt
    v_add_u32 v23, 7168, v23
    s_add_u32 m0, s51, 2048
    s_nop 0
    global_load_lds_dwordx4 v23, s[16:17] offset:0 nt
    v_add_u32 v23, 7168, v23
    s_add_u32 m0, s51, 3072
    s_nop 0
    global_load_lds_dwordx4 v23, s[16:17] offset:0 nt
    v_add_u32 v23, 7168, v23
    s_add_u32 s53, s53, 4
    s_waitcnt vmcnt(24)
    s_sub_u32 s50, s53, 24
    s_max_i32 s58, s58, s50
    v_mov_b32 v22, s58
    ds_write_b32 v122, v22
    s_add_u32 m0, s51, 4096
    s_nop 0
    global_load_lds_dwordx4 v23, s[16:17] offset:0 nt
    v_add_u32 v23, 7168, v23
    s_add_u32 m0, s51, 5120
    s_nop 0
    global_load_lds_dwordx4 v23, s[16:17] offset:0 nt
    v_add_u32 v23, 7168, v23
    s_add_u32 m0, s51, 6144
    s_nop 0
    global_load_lds_dwordx4 v23, s[16:17] offset:0 nt
    v_add_u32 v23, 7168, v23
    s_add_u32 m0, s51, 7168
    s_nop 0
    global_load_lds_dwordx4 v23, s[16:17] offset:0 nt
    s_add_u32 s53, s53, 4
    s_add_u32 s65, s65, 1
    s_sub_u32 s49, s49, 1
    s_cmp_lg_u32 s49, 0
    s_cbranch_scc1 L_ld_e1bb
    s_branch L_ld_e3b
L_ld_e2b:
    s_sleep 55
L_ld_e3b:
    s_mov_b32 s65, 0
    s_waitcnt vmcnt(24)
    s_sub_u32 s50, s53, 24
    s_max_i32 s58, s58, s50
    v_mov_b32 v22, s58
    ds_write_b32 v122, v22
    s_movk_i32 s49, 8
L_ld_e2lb:
    s_add_u32 s38, s64, s65
    s_and_b32 s38, s38, 7
    s_mul_i32 s39, s38, 57344
    s_mul_i32 s51, s38, 7168
    s_add_u32 s51, s51, 92160
    v_add_u32 v23, s39, v21
    s_waitcnt vmcnt(20)
    s_sub_u32 s50, s53, 20
    s_max_i32 s58, s58, s50
    v_mov_b32 v22, s58
    ds_write_b32 v122, v22
    s_add_u32 m0, s51, 0
    s_nop 0
    global_load_lds_dwordx4 v23, s[20:21] offset:0 nt
    v_add_u32 v23, 8192, v23
    s_add_u32 m0, s51, 1024
    s_nop 0
    global_load_lds_dwordx4 v23, s[20:21] offset:0 nt
    v_add_u32 v23, 8192, v23
    s_add_u32 m0, s51, 2048
    s_nop 0
    global_load_lds_dwordx4 v23, s[20:21] offset:0 nt
    v_add_u32 v23, 8192, v23
    s_add_u32 m0, s51, 3072
    s_nop 0
    global_load_lds_dwordx4 v23, s[20:21] offset:0 nt
    v_add_u32 v23, 8192, v23
    s_add_u32 s53, s53, 4
    s_waitcnt vmcnt(21)
    s_sub_u32 s50, s53, 21
    s_max_i32 s58, s58, s50
    v_mov_b32 v22, s58
    ds_write_b32 v122, v22
    s_add_u32 m0, s51, 4096
    s_nop 0
    global_load_lds_dwordx4 v23, s[20:21] offset:0 nt
    v_add_u32 v23, 8192, v23
    s_add_u32 m0, s51, 5120
    s_nop 0
    global_load_lds_dwordx4 v23, s[20:21] offset:0 nt
    v_add_u32 v23, 8192, v23
    s_add_u32 m0, s51, 6144
    s_nop 0
    global_load_lds_dwordx4 v23, s[20:21] offset:0 nt
    s_add_u32 s53, s53, 3
    s_add_u32 s65, s65, 1
    s_sub_u32 s49, s49, 1
    s_cmp_lg_u32 s49, 0
    s_cbranch_scc1 L_ld_e2lb
    s_waitcnt vmcnt(20)
    s_sub_u32 s50, s53, 20
    s_max_i32 s58, s58, s50
    v_mov_b32 v22, s58
    ds_write_b32 v122, v22
    s_waitcnt vmcnt(16)
    s_sub_u32 s50, s53, 16
    s_max_i32 s58, s58, s50
    v_mov_b32 v22, s58
    ds_write_b32 v122, v22
    s_waitcnt vmcnt(12)
    s_sub_u32 s50, s53, 12
    s_max_i32 s58, s58, s50
    v_mov_b32 v22, s58
    ds_write_b32 v122, v22
    s_waitcnt vmcnt(8)
    s_sub_u32 s50, s53, 8
    s_max_i32 s58, s58, s50
    v_mov_b32 v22, s58
    ds_write_b32 v122, v22
    s_waitcnt vmcnt(6)
    s_sub_u32 s50, s53, 6
    s_max_i32 s58, s58, s50
    v_mov_b32 v22, s58
    ds_write_b32 v122, v22
    s_waitcnt vmcnt(4)
    s_sub_u32 s50, s53, 4
    s_max_i32 s58, s58, s50
    v_mov_b32 v22, s58
    ds_write_b32 v122, v22
    s_waitcnt vmcnt(2)
    s_sub_u32 s50, s53, 2
    s_max_i32 s58, s58, s50
    v_mov_b32 v22, s58
    ds_write_b32 v122, v22
    s_waitcnt vmcnt(0)
    s_sub_u32 s50, s53, 0
    s_max_i32 s58, s58, s50
    v_mov_b32 v22, s58
    ds_write_b32 v122, v22
    s_waitcnt lgkmcnt(0)
    s_branch L_ld_end
L_ld_l:
    s_lshl_b32 s38, s33, 24
    s_lshl_b32 s39, s34, 15
    s_add_u32 s38, s38, s39
    s_add_u32 s38, s38, 15728640
    v_xor_b32 v7, v6, v5
    v_lshlrev_b32 v20, 8, v5
    v_lshl_add_u32 v20, v7, 4, v20
    v_add_u32 v20, s38, v20
    v_bfe_u32 v7, v1, 1, 3
    v_lshlrev_b32 v21, 8, v7
    v_lshl_add_u32 v21, v3, 5, v21
    v_and_b32 v7, 1, v1
    v_lshl_add_u32 v21, v7, 4, v21
    v_add_u32 v21, s38, v21
    s_mov_b32 s53, 0
    s_mov_b32 s65, 0
    s_cmp_ge_u32 s31, 4
    s_cbranch_scc1 L_ld_llate
    s_movk_i32 s49, 8
L_ld_ka:
    s_add_u32 s38, s64, s65
    s_and_b32 s38, s38, 7
    s_mul_i32 s39, s38, 4096
    s_mul_i32 s51, s38, 4096
    s_add_u32 s51, s51, 26624
    v_add_u32 v23, s39, v20
    s_waitcnt vmcnt(28)
    s_sub_u32 s50, s53, 28
    s_max_i32 s58, s58, s50
    v_mov_b32 v22, s58
    ds_write_b32 v122, v22
    s_add_u32 m0, s51, 0
    s_nop 0
    global_load_lds_dwordx4 v23, s[6:7] offset:0 nt
    s_add_u32 m0, s51, 896
    s_nop 0
    global_load_lds_dwordx4 v23, s[6:7] offset:128 nt
    s_add_u32 m0, s51, 0
    s_nop 0
    global_load_lds_dwordx4 v23, s[6:7] offset:2048 nt
    s_add_u32 m0, s51, 896
    s_nop 0
    global_load_lds_dwordx4 v23, s[6:7] offset:2176 nt
    s_add_u32 s53, s53, 4
    s_add_u32 s65, s65, 1
    s_sub_u32 s49, s49, 1
    s_cmp_lg_u32 s49, 0
    s_cbranch_scc1 L_ld_ka
    s_mov_b32 s65, 0
    s_movk_i32 s49, 8
L_ld_va:
    s_add_u32 s38, s64, s65
    s_and_b32 s38, s38, 7
    s_mul_i32 s39, s38, 4096
    s_mul_i32 s51, s38, 4096
    s_add_u32 s51, s51, 59392
    v_add_u32 v23, s39, v21
    s_waitcnt vmcnt(28)
    s_sub_u32 s50, s53, 28
    s_max_i32 s58, s58, s50
    v_mov_b32 v22, s58
    ds_write_b32 v122, v22
    s_add_u32 m0, s51, 0
    s_nop 0
    global_load_lds_dwordx4 v23, s[8:9] offset:0 nt
    s_add_u32 m0, s51, 896
    s_nop 0
    global_load_lds_dwordx4 v23, s[8:9] offset:128 nt
    s_add_u32 m0, s51, 0
    s_nop 0
    global_load_lds_dwordx4 v23, s[8:9] offset:2048 nt
    s_add_u32 m0, s51, 896
    s_nop 0
    global_load_lds_dwordx4 v23, s[8:9] offset:2176 nt
    s_add_u32 s53, s53, 4
    s_add_u32 s65, s65, 1
    s_sub_u32 s49, s49, 1
    s_cmp_lg_u32 s49, 0
    s_cbranch_scc1 L_ld_va
    s_lshl_b32 s38, s42, 18
    s_lshl_b32 s39, s43, 9
    s_add_u32 s38, s38, s39
    v_lshlrev_b32 v20, 11, v3
    v_lshl_add_u32 v20, v4, 4, v20
    v_add_u32 v20, s38, v20
    s_mov_b32 s65, 0
    s_movk_i32 s49, 2
L_ld_opa:
    s_add_u32 s38, s64, s65
    s_and_b32 s38, s38, 7
    s_mul_i32 s39, s38, 32768
    s_mul_i32 s51, s38, 8192
    s_add_u32 s51, s51, 92160
    v_add_u32 v23, s39, v20
    s_waitcnt vmcnt(28)
    s_sub_u32 s50, s53, 28
    s_max_i32 s58, s58, s50
    v_mov_b32 v22, s58
    ds_write_b32 v122, v22
    s_add_u32 m0, s51, 0
    s_nop 0
    global_load_lds_dwordx4 v23, s[12:13] offset:0 nt
    s_add_u32 m0, s51, 768
    s_nop 0
    global_load_lds_dwordx4 v23, s[12:13] offset:256 nt
    v_add_u32 v23, 8192, v23
    s_add_u32 m0, s51, 2048
    s_nop 0
    global_load_lds_dwordx4 v23, s[12:13] offset:0 nt
    s_add_u32 m0, s51, 2816
    s_nop 0
    global_load_lds_dwordx4 v23, s[12:13] offset:256 nt
    v_add_u32 v23, 8192, v23
    s_add_u32 s53, s53, 4
    s_waitcnt vmcnt(28)
    s_sub_u32 s50, s53, 28
    s_max_i32 s58, s58, s50
    v_mov_b32 v22, s58
    ds_write_b32 v122, v22
    s_add_u32 m0, s51, 4096
    s_nop 0
    global_load_lds_dwordx4 v23, s[12:13] offset:0 nt
    s_add_u32 m0, s51, 4864
    s_nop 0
    global_load_lds_dwordx4 v23, s[12:13] offset:256 nt
    v_add_u32 v23, 8192, v23
    s_add_u32 m0, s51, 6144
    s_nop 0
    global_load_lds_dwordx4 v23, s[12:13] offset:0 nt
    s_add_u32 m0, s51, 6912
    s_nop 0
    global_load_lds_dwordx4 v23, s[12:13] offset:256 nt
    s_add_u32 s53, s53, 4
    s_add_u32 s65, s65, 1
    s_sub_u32 s49, s49, 1
    s_cmp_lg_u32 s49, 0
    s_cbranch_scc1 L_ld_opa
    s_waitcnt vmcnt(28)
    s_sub_u32 s50, s53, 28
    s_max_i32 s58, s58, s50
    v_mov_b32 v22, s58
    ds_write_b32 v122, v22
    s_waitcnt vmcnt(24)
    s_sub_u32 s50, s53, 24
    s_max_i32 s58, s58, s50
    v_mov_b32 v22, s58
    ds_write_b32 v122, v22
    s_waitcnt vmcnt(20)
    s_sub_u32 s50, s53, 20
    s_max_i32 s58, s58, s50
    v_mov_b32 v22, s58
    ds_write_b32 v122, v22
    s_waitcnt vmcnt(16)
    s_sub_u32 s50, s53, 16
    s_max_i32 s58, s58, s50
    v_mov_b32 v22, s58
    ds_write_b32 v122, v22
    s_waitcnt vmcnt(12)
    s_sub_u32 s50, s53, 12
    s_max_i32 s58, s58, s50
    v_mov_b32 v22, s58
    ds_write_b32 v122, v22
    s_waitcnt vmcnt(8)
    s_sub_u32 s50, s53, 8
    s_max_i32 s58, s58, s50
    v_mov_b32 v22, s58
    ds_write_b32 v122, v22
    s_waitcnt vmcnt(6)
    s_sub_u32 s50, s53, 6
    s_max_i32 s58, s58, s50
    v_mov_b32 v22, s58
    ds_write_b32 v122, v22
    s_waitcnt vmcnt(4)
    s_sub_u32 s50, s53, 4
    s_max_i32 s58, s58, s50
    v_mov_b32 v22, s58
    ds_write_b32 v122, v22
    s_waitcnt vmcnt(2)
    s_sub_u32 s50, s53, 2
    s_max_i32 s58, s58, s50
    v_mov_b32 v22, s58
    ds_write_b32 v122, v22
    s_waitcnt vmcnt(0)
    s_sub_u32 s50, s53, 0
    s_max_i32 s58, s58, s50
    v_mov_b32 v22, s58
    ds_write_b32 v122, v22
    s_waitcnt lgkmcnt(0)
    s_mov_b32 s49, 0
L_ld_qwa:
    ds_read_b32 v24, v122 offset:4
    s_add_u32 s49, s49, 1
    s_waitcnt lgkmcnt(0)
    v_readfirstlane_b32 s50, v24
    s_cmp_ge_u32 s50, 8
    s_cbranch_scc1 L_ld_qda
    s_cmp_gt_u32 s49, 800000
    s_cbranch_scc1 L_ld_qda
    s_sleep 1
    s_branch L_ld_qwa
L_ld_qda:
    s_movk_i32 s49, 6
L_ld_oa:
    s_add_u32 s38, s64, s65
    s_and_b32 s38, s38, 7
    s_mul_i32 s39, s38, 32768
    s_mul_i32 s51, s38, 8192
    s_add_u32 s51, s51, 92160
    v_add_u32 v23, s39, v20
    s_waitcnt vmcnt(24)
    s_sub_u32 s50, s53, 24
    s_max_i32 s58, s58, s50
    v_mov_b32 v22, s58
    ds_write_b32 v122, v22
    s_add_u32 m0, s51, 0
    s_nop 0
    global_load_lds_dwordx4 v23, s[12:13] offset:0 nt
    s_add_u32 m0, s51, 768
    s_nop 0
    global_load_lds_dwordx4 v23, s[12:13] offset:256 nt
    v_add_u32 v23, 8192, v23
    s_add_u32 m0, s51, 2048
    s_nop 0
    global_load_lds_dwordx4 v23, s[12:13] offset:0 nt
    s_add_u32 m0, s51, 2816
    s_nop 0
    global_load_lds_dwordx4 v23, s[12:13] offset:256 nt
    v_add_u32 v23, 8192, v23
    s_add_u32 s53, s53, 4
    s_waitcnt vmcnt(24)
    s_sub_u32 s50, s53, 24
    s_max_i32 s58, s58, s50
    v_mov_b32 v22, s58
    ds_write_b32 v122, v22
    s_add_u32 m0, s51, 4096
    s_nop 0
    global_load_lds_dwordx4 v23, s[12:13] offset:0 nt
    s_add_u32 m0, s51, 4864
    s_nop 0
    global_load_lds_dwordx4 v23, s[12:13] offset:256 nt
    v_add_u32 v23, 8192, v23
    s_add_u32 m0, s51, 6144
    s_nop 0
    global_load_lds_dwordx4 v23, s[12:13] offset:0 nt
    s_add_u32 m0, s51, 6912
    s_nop 0
    global_load_lds_dwordx4 v23, s[12:13] offset:256 nt
    s_add_u32 s53, s53, 4
    s_add_u32 s65, s65, 1
    s_sub_u32 s49, s49, 1
    s_cmp_lg_u32 s49, 0
    s_cbranch_scc1 L_ld_oa
    s_waitcnt vmcnt(24)
    s_sub_u32 s50, s53, 24
    s_max_i32 s58, s58, s50
    v_mov_b32 v22, s58
    ds_write_b32 v122, v22
    s_waitcnt vmcnt(20)
    s_sub_u32 s50, s53, 20
    s_max_i32 s58, s58, s50
    v_mov_b32 v22, s58
    ds_write_b32 v122, v22
    s_waitcnt vmcnt(16)
    s_sub_u32 s50, s53, 16
    s_max_i32 s58, s58, s50
    v_mov_b32 v22, s58
    ds_write_b32 v122, v22
    s_waitcnt vmcnt(12)
    s_sub_u32 s50, s53, 12
    s_max_i32 s58, s58, s50
    v_mov_b32 v22, s58
    ds_write_b32 v122, v22
    s_waitcnt vmcnt(8)
    s_sub_u32 s50, s53, 8
    s_max_i32 s58, s58, s50
    v_mov_b32 v22, s58
    ds_write_b32 v122, v22
    s_waitcnt vmcnt(6)
    s_sub_u32 s50, s53, 6
    s_max_i32 s58, s58, s50
    v_mov_b32 v22, s58
    ds_write_b32 v122, v22
    s_waitcnt vmcnt(4)
    s_sub_u32 s50, s53, 4
    s_max_i32 s58, s58, s50
    v_mov_b32 v22, s58
    ds_write_b32 v122, v22
    s_waitcnt vmcnt(2)
    s_sub_u32 s50, s53, 2
    s_max_i32 s58, s58, s50
    v_mov_b32 v22, s58
    ds_write_b32 v122, v22
    s_waitcnt vmcnt(0)
    s_sub_u32 s50, s53, 0
    s_max_i32 s58, s58, s50
    v_mov_b32 v22, s58
    ds_write_b32 v122, v22
    s_waitcnt lgkmcnt(0)
    s_branch L_ld_end
L_ld_llate:
    s_movk_i32 s49, 8
L_ld_kb:
    s_add_u32 s38, s64, s65
    s_and_b32 s38, s38, 7
    s_mul_i32 s39, s38, 4096
    s_mul_i32 s51, s38, 4096
    s_add_u32 s51, s51, 26624
    v_add_u32 v23, s39, v20
    s_waitcnt vmcnt(28)
    s_sub_u32 s50, s53, 28
    s_max_i32 s58, s58, s50
    v_mov_b32 v22, s58
    ds_write_b32 v122, v22
    s_add_u32 m0, s51, 0
    s_nop 0
    global_load_lds_dwordx4 v23, s[6:7] offset:0 nt
    s_add_u32 m0, s51, 896
    s_nop 0
    global_load_lds_dwordx4 v23, s[6:7] offset:128 nt
    s_add_u32 m0, s51, 0
    s_nop 0
    global_load_lds_dwordx4 v23, s[6:7] offset:2048 nt
    s_add_u32 m0, s51, 896
    s_nop 0
    global_load_lds_dwordx4 v23, s[6:7] offset:2176 nt
    s_add_u32 s53, s53, 4
    s_add_u32 s65, s65, 1
    s_sub_u32 s49, s49, 1
    s_cmp_lg_u32 s49, 0
    s_cbranch_scc1 L_ld_kb
    s_mov_b32 s65, 0
    s_movk_i32 s49, 8
L_ld_vb:
    s_add_u32 s38, s64, s65
    s_and_b32 s38, s38, 7
    s_mul_i32 s39, s38, 4096
    s_mul_i32 s51, s38, 4096
    s_add_u32 s51, s51, 59392
    v_add_u32 v23, s39, v21
    s_waitcnt vmcnt(28)
    s_sub_u32 s50, s53, 28
    s_max_i32 s58, s58, s50
    v_mov_b32 v22, s58
    ds_write_b32 v122, v22
    s_add_u32 m0, s51, 0
    s_nop 0
    global_load_lds_dwordx4 v23, s[8:9] offset:0 nt
    s_add_u32 m0, s51, 896
    s_nop 0
    global_load_lds_dwordx4 v23, s[8:9] offset:128 nt
    s_add_u32 m0, s51, 0
    s_nop 0
    global_load_lds_dwordx4 v23, s[8:9] offset:2048 nt
    s_add_u32 m0, s51, 896
    s_nop 0
    global_load_lds_dwordx4 v23, s[8:9] offset:2176 nt
    s_add_u32 s53, s53, 4
    s_add_u32 s65, s65, 1
    s_sub_u32 s49, s49, 1
    s_cmp_lg_u32 s49, 0
    s_cbranch_scc1 L_ld_vb
    s_lshl_b32 s38, s42, 18
    s_lshl_b32 s39, s43, 9
    s_add_u32 s38, s38, s39
    v_lshlrev_b32 v20, 11, v3
    v_lshl_add_u32 v20, v4, 4, v20
    v_add_u32 v20, s38, v20
    s_mov_b32 s65, 0
    s_movk_i32 s49, 2
L_ld_opb:
    s_add_u32 s38, s64, s65
    s_and_b32 s38, s38, 7
    s_mul_i32 s39, s38, 32768
    s_mul_i32 s51, s38, 8192
    s_add_u32 s51, s51, 92160
    v_add_u32 v23, s39, v20
    s_waitcnt vmcnt(28)
    s_sub_u32 s50, s53, 28
    s_max_i32 s58, s58, s50
    v_mov_b32 v22, s58
    ds_write_b32 v122, v22
    s_add_u32 m0, s51, 0
    s_nop 0
    global_load_lds_dwordx4 v23, s[12:13] offset:0 nt
    s_add_u32 m0, s51, 768
    s_nop 0
    global_load_lds_dwordx4 v23, s[12:13] offset:256 nt
    v_add_u32 v23, 8192, v23
    s_add_u32 m0, s51, 2048
    s_nop 0
    global_load_lds_dwordx4 v23, s[12:13] offset:0 nt
    s_add_u32 m0, s51, 2816
    s_nop 0
    global_load_lds_dwordx4 v23, s[12:13] offset:256 nt
    v_add_u32 v23, 8192, v23
    s_add_u32 s53, s53, 4
    s_waitcnt vmcnt(28)
    s_sub_u32 s50, s53, 28
    s_max_i32 s58, s58, s50
    v_mov_b32 v22, s58
    ds_write_b32 v122, v22
    s_add_u32 m0, s51, 4096
    s_nop 0
    global_load_lds_dwordx4 v23, s[12:13] offset:0 nt
    s_add_u32 m0, s51, 4864
    s_nop 0
    global_load_lds_dwordx4 v23, s[12:13] offset:256 nt
    v_add_u32 v23, 8192, v23
    s_add_u32 m0, s51, 6144
    s_nop 0
    global_load_lds_dwordx4 v23, s[12:13] offset:0 nt
    s_add_u32 m0, s51, 6912
    s_nop 0
    global_load_lds_dwordx4 v23, s[12:13] offset:256 nt
    s_add_u32 s53, s53, 4
    s_add_u32 s65, s65, 1
    s_sub_u32 s49, s49, 1
    s_cmp_lg_u32 s49, 0
    s_cbranch_scc1 L_ld_opb
    s_waitcnt vmcnt(28)
    s_sub_u32 s50, s53, 28
    s_max_i32 s58, s58, s50
    v_mov_b32 v22, s58
    ds_write_b32 v122, v22
    s_waitcnt vmcnt(24)
    s_sub_u32 s50, s53, 24
    s_max_i32 s58, s58, s50
    v_mov_b32 v22, s58
    ds_write_b32 v122, v22
    s_waitcnt vmcnt(20)
    s_sub_u32 s50, s53, 20
    s_max_i32 s58, s58, s50
    v_mov_b32 v22, s58
    ds_write_b32 v122, v22
    s_waitcnt vmcnt(16)
    s_sub_u32 s50, s53, 16
    s_max_i32 s58, s58, s50
    v_mov_b32 v22, s58
    ds_write_b32 v122, v22
    s_waitcnt vmcnt(12)
    s_sub_u32 s50, s53, 12
    s_max_i32 s58, s58, s50
    v_mov_b32 v22, s58
    ds_write_b32 v122, v22
    s_waitcnt vmcnt(8)
    s_sub_u32 s50, s53, 8
    s_max_i32 s58, s58, s50
    v_mov_b32 v22, s58
    ds_write_b32 v122, v22
    s_waitcnt vmcnt(6)
    s_sub_u32 s50, s53, 6
    s_max_i32 s58, s58, s50
    v_mov_b32 v22, s58
    ds_write_b32 v122, v22
    s_waitcnt vmcnt(4)
    s_sub_u32 s50, s53, 4
    s_max_i32 s58, s58, s50
    v_mov_b32 v22, s58
    ds_write_b32 v122, v22
    s_waitcnt vmcnt(2)
    s_sub_u32 s50, s53, 2
    s_max_i32 s58, s58, s50
    v_mov_b32 v22, s58
    ds_write_b32 v122, v22
    s_waitcnt vmcnt(0)
    s_sub_u32 s50, s53, 0
    s_max_i32 s58, s58, s50
    v_mov_b32 v22, s58
    ds_write_b32 v122, v22
    s_waitcnt lgkmcnt(0)
    s_mov_b32 s49, 0
L_ld_qwb:
    ds_read_b32 v24, v122 offset:4
    s_add_u32 s49, s49, 1
    s_waitcnt lgkmcnt(0)
    v_readfirstlane_b32 s50, v24
    s_cmp_ge_u32 s50, 8
    s_cbranch_scc1 L_ld_qdb
    s_cmp_gt_u32 s49, 800000
    s_cbranch_scc1 L_ld_qdb
    s_sleep 1
    s_branch L_ld_qwb
L_ld_qdb:
    s_movk_i32 s49, 6
L_ld_ob:
    s_add_u32 s38, s64, s65
    s_and_b32 s38, s38, 7
    s_mul_i32 s39, s38, 32768
    s_mul_i32 s51, s38, 8192
    s_add_u32 s51, s51, 92160
    v_add_u32 v23, s39, v20
    s_waitcnt vmcnt(24)
    s_sub_u32 s50, s53, 24
    s_max_i32 s58, s58, s50
    v_mov_b32 v22, s58
    ds_write_b32 v122, v22
    s_add_u32 m0, s51, 0
    s_nop 0
    global_load_lds_dwordx4 v23, s[12:13] offset:0 nt
    s_add_u32 m0, s51, 768
    s_nop 0
    global_load_lds_dwordx4 v23, s[12:13] offset:256 nt
    v_add_u32 v23, 8192, v23
    s_add_u32 m0, s51, 2048
    s_nop 0
    global_load_lds_dwordx4 v23, s[12:13] offset:0 nt
    s_add_u32 m0, s51, 2816
    s_nop 0
    global_load_lds_dwordx4 v23, s[12:13] offset:256 nt
    v_add_u32 v23, 8192, v23
    s_add_u32 s53, s53, 4
    s_waitcnt vmcnt(24)
    s_sub_u32 s50, s53, 24
    s_max_i32 s58, s58, s50
    v_mov_b32 v22, s58
    ds_write_b32 v122, v22
    s_add_u32 m0, s51, 4096
    s_nop 0
    global_load_lds_dwordx4 v23, s[12:13] offset:0 nt
    s_add_u32 m0, s51, 4864
    s_nop 0
    global_load_lds_dwordx4 v23, s[12:13] offset:256 nt
    v_add_u32 v23, 8192, v23
    s_add_u32 m0, s51, 6144
    s_nop 0
    global_load_lds_dwordx4 v23, s[12:13] offset:0 nt
    s_add_u32 m0, s51, 6912
    s_nop 0
    global_load_lds_dwordx4 v23, s[12:13] offset:256 nt
    s_add_u32 s53, s53, 4
    s_add_u32 s65, s65, 1
    s_sub_u32 s49, s49, 1
    s_cmp_lg_u32 s49, 0
    s_cbranch_scc1 L_ld_ob
    s_waitcnt vmcnt(24)
    s_sub_u32 s50, s53, 24
    s_max_i32 s58, s58, s50
    v_mov_b32 v22, s58
    ds_write_b32 v122, v22
    s_waitcnt vmcnt(20)
    s_sub_u32 s50, s53, 20
    s_max_i32 s58, s58, s50
    v_mov_b32 v22, s58
    ds_write_b32 v122, v22
    s_waitcnt vmcnt(16)
    s_sub_u32 s50, s53, 16
    s_max_i32 s58, s58, s50
    v_mov_b32 v22, s58
    ds_write_b32 v122, v22
    s_waitcnt vmcnt(12)
    s_sub_u32 s50, s53, 12
    s_max_i32 s58, s58, s50
    v_mov_b32 v22, s58
    ds_write_b32 v122, v22
    s_waitcnt vmcnt(8)
    s_sub_u32 s50, s53, 8
    s_max_i32 s58, s58, s50
    v_mov_b32 v22, s58
    ds_write_b32 v122, v22
    s_waitcnt vmcnt(6)
    s_sub_u32 s50, s53, 6
    s_max_i32 s58, s58, s50
    v_mov_b32 v22, s58
    ds_write_b32 v122, v22
    s_waitcnt vmcnt(4)
    s_sub_u32 s50, s53, 4
    s_max_i32 s58, s58, s50
    v_mov_b32 v22, s58
    ds_write_b32 v122, v22
    s_waitcnt vmcnt(2)
    s_sub_u32 s50, s53, 2
    s_max_i32 s58, s58, s50
    v_mov_b32 v22, s58
    ds_write_b32 v122, v22
    s_waitcnt vmcnt(0)
    s_sub_u32 s50, s53, 0
    s_max_i32 s58, s58, s50
    v_mov_b32 v22, s58
    ds_write_b32 v122, v22
    s_waitcnt lgkmcnt(0)
    s_branch L_ld_end
L_ld_end:
L_exit:
    s_endpgm
    .fill 2048, 4, 0xBF800000
.section .rodata,"a"
.p2align 6
.amdhsa_kernel parallel_sum__sliding_block_cached__mixer_channel_mlp__decode_kernel
  .amdhsa_next_free_vgpr 168
  .amdhsa_next_free_sgpr 72
  .amdhsa_accum_offset 168
  .amdhsa_group_segment_fixed_size 0
  .amdhsa_kernarg_size 104
  .amdhsa_user_sgpr_count 2
  .amdhsa_user_sgpr_kernarg_segment_ptr 1
  .amdhsa_system_sgpr_workgroup_id_x 1
.end_amdhsa_kernel
```
